```python
import torch

def _softmax(x, axis=-1):
    return torch.softmax(x, dim=axis)
def _gelu(x):
    return torch.nn.functional.gelu(x, approximate="tanh")
def _silu(x):
    return torch.nn.functional.silu(x)
def _sigmoid(x):
    return torch.sigmoid(x)
def _layernorm(x, axis=-1, eps=1e-5):
    m = x.mean(dim=axis, keepdim=True)
    v = x.var(dim=axis, keepdim=True, unbiased=False)
    return (x - m) / torch.sqrt(v + eps)
def _scatter_add(tgt, idx, src, axis=0):
    return tgt.clone().index_add_(axis, idx, src)
def _segment_sum(src, seg, n):
    out = torch.zeros((n,) + src.shape[1:], dtype=src.dtype)
    return out.index_add_(0, seg, src)
def _pad(x, pw):
    flat = tuple(v for pair in reversed(pw) for v in pair)
    return torch.nn.functional.pad(x, flat)

kernel_name = 'standalone__swiglu_ffn__sampling'

def setup_inputs():

    _w = (lambda a: (lambda t: t.to(torch.bfloat16) if t.is_floating_point() else t)(torch.as_tensor(a)))
    B, S, D, F = 32, 32, 1024, 3584
    return {
        "x": _w((lambda *s: torch.randn(*s, dtype=torch.bfloat16) * 0.05)(B, S, D)),
        "w_gate": _w((lambda *s: torch.randn(*s, dtype=torch.bfloat16) * 0.05)(D, F)),
        "w_up": _w((lambda *s: torch.randn(*s, dtype=torch.bfloat16) * 0.05)(D, F)),
        "w_down": _w((lambda *s: torch.randn(*s, dtype=torch.bfloat16) * 0.05)(F, D)),
    }

def reference(x, w_gate, w_up, w_down):
    g = _silu(x @ w_gate)
    u = x @ w_up
    return (g * u) @ w_down
```

```asm
; @launch grid=(256,1,1) block=(512,1,1) lds=163840
.amdgcn_target "amdgcn-amd-amdhsa--gfx950"
.text
.globl standalone__swiglu_ffn__sampling_kernel
.p2align 12
.type standalone__swiglu_ffn__sampling_kernel,@function
standalone__swiglu_ffn__sampling_kernel:
    s_cmp_ge_u32 s2, 256
    s_cbranch_scc1 L_END
    s_load_dwordx8 s[4:11], s[0:1], 0
    s_load_dwordx4 s[12:15], s[0:1], 32
    s_load_dwordx2 s[16:17], s[0:1], 48
    s_mov_b64 exec, -1
    v_lshrrev_b32 v1, 6, v0
    v_and_b32 v2, 63, v0
    v_readfirstlane_b32 s48, v1
    s_and_b32 s53, s2, 7
    s_lshr_b32 s54, s2, 3
    s_lshr_b32 s59, s53, 1
    s_and_b32 s50, s53, 1
    s_lshl_b32 s50, s50, 2
    s_lshr_b32 s56, s54, 3
    s_add_u32 s50, s50, s56
    s_and_b32 s49, s54, 7
    s_mul_i32 s55, s53, 28
    s_add_u32 s55, s55, s54
    s_sub_u32 s55, s55, s56
    s_lshr_b32 s51, s55, 3
    s_and_b32 s52, s55, 7
    s_mov_b32 s63, 0
    s_cmp_eq_u32 s49, 7
    s_cbranch_scc1 L_SPARE
    s_cmp_lt_u32 s48, 4
    s_cbranch_scc0 L_LOADER
    s_mov_b64 exec, 0
    s_getpc_b64 s[64:65]
L_GPC:
    s_add_u32 s64, s64, L_TAB-L_GPC
    s_addc_u32 s65, s65, 0
    s_mul_i32 s68, s48, 8
    s_add_u32 s69, s68, 8
    s_lshr_b32 s70, s2, 3
    s_lshl_b32 s70, s70, 2
    s_add_u32 s70, s70, s48
    s_mul_i32 s70, s70, 8
    s_lshr_b32 s70, s70, 7
    s_lshl_b32 s70, s70, 2
    s_branch L_DJ
L_DISP:
    s_cmp_ge_u32 s68, s69
    s_cbranch_scc1 L_DRET
    s_mov_b32 s70, s68
    s_add_u32 s68, s68, 4
L_DJ:
    s_add_u32 s66, s64, s70
    s_addc_u32 s67, s65, 0
    s_setpc_b64 s[66:67]
L_TAB:
    s_branch L_PAD_comp
    s_branch L_PAD_comp.4
    s_branch L_PAD_comp.3
    s_branch L_PAD_ent.4
    s_branch L_PAD_p2m
    s_branch L_PAD_p2m.4
    s_branch L_PAD_p2h
    s_branch L_PAD_comp.8
L_DRET:
    s_mov_b64 exec, -1
    s_branch L_COMPUTE
L_LOADER:
    s_sub_u32 s55, s48, 4
    v_lshrrev_b32 v3, 3, v2
    s_and_b32 s54, s55, 1
    s_lshl_b32 s53, s54, 3
    v_add_u32 v3, s53, v3
    v_lshlrev_b32 v3, 11, v3
    v_lshrrev_b32 v4, 4, v2
    s_lshl_b32 s53, s54, 2
    v_add_u32 v5, s53, v4
    v_and_b32 v11, 7, v2
    v_xor_b32 v5, v5, v11
    v_lshl_add_u32 v3, v5, 4, v3
    s_lshr_b32 s53, s55, 1
    s_add_u32 s53, s53, s59
    s_add_u32 s53, s53, 1
    s_and_b32 s53, s53, 3
    s_lshl_b32 s53, s53, 15
    v_add_u32 v11, s53, v3
    v_xor_b32 v12, 65536, v11
    s_lshl_b32 s53, s55, 2
    v_add_u32 v3, s53, v4
    s_movk_i32 s53, 7168
    v_mul_lo_u32 v3, v3, s53
    s_lshr_b32 s53, s55, 1
    s_lshl_b32 s53, s53, 2
    v_add_u32 v4, s53, v4
    v_lshlrev_b32 v4, 1, v4
    v_and_b32 v5, 15, v2
    v_xor_b32 v4, v4, v5
    v_lshl_add_u32 v13, v4, 4, v3
    v_add_u32 v14, 114688, v13
    s_lshl_b32 s56, s55, 10
    s_lshl_b32 s57, s52, 18
    s_lshl_b32 s58, s51, 8
    v_lshrrev_b32 v3, 1, v2
    v_lshlrev_b32 v3, 4, v3
    s_lshl_b32 s53, s52, 1
    s_lshr_b32 s54, s55, 1
    s_add_u32 s53, s53, s54
    s_add_u32 s53, s53, 32
    v_add_u32 v3, s53, v3
    s_movk_i32 s53, 7168
    v_mul_lo_u32 v3, v3, s53
    v_and_b32 v4, 1, v2
    v_lshl_add_u32 v15, v4, 7, v3
    s_waitcnt lgkmcnt(0)
    s_mov_b32 s20, s4
    s_and_b32 s21, s5, 0xffff
    s_mov_b32 s22, 2097152
    s_mov_b32 s23, 0x00020000
    s_mov_b32 s24, s6
    s_and_b32 s25, s7, 0xffff
    s_mov_b32 s26, 7340032
    s_mov_b32 s27, 0x00020000
    s_mov_b32 s28, s8
    s_and_b32 s29, s9, 0xffff
    s_mov_b32 s30, 7340032
    s_mov_b32 s31, 0x00020000
    s_add_u32 s53, s57, 0
    s_add_u32 m0, s56, 32768
    s_nop 0
    buffer_load_dwordx4 v11, s[20:23], s53 offen lds
    s_add_u32 m0, s56, 36864
    s_nop 0
    buffer_load_dwordx4 v12, s[20:23], s53 offen lds
    s_add_u32 s53, s57, 131072
    s_add_u32 m0, s56, 40960
    s_nop 0
    buffer_load_dwordx4 v11, s[20:23], s53 offen lds
    s_add_u32 m0, s56, 45056
    s_nop 0
    buffer_load_dwordx4 v12, s[20:23], s53 offen lds
    s_add_u32 s53, s58, 0
    s_add_u32 m0, s56, 114688
    s_nop 0
    buffer_load_dwordx4 v13, s[24:27], s53 offen lds
    s_add_u32 m0, s56, 122880
    s_nop 0
    buffer_load_dwordx4 v13, s[28:31], s53 offen lds
    s_add_u32 m0, s56, 118784
    s_nop 0
    buffer_load_dwordx4 v14, s[24:27], s53 offen lds
    s_add_u32 m0, s56, 126976
    s_nop 0
    buffer_load_dwordx4 v14, s[28:31], s53 offen lds
    s_bitcmp0_b32 s55, 0
    s_cselect_b32 s32, s6, s8
    s_cselect_b32 s33, s7, s9
    s_and_b32 s33, s33, 0xffff
    s_mov_b32 s34, 7340032
    s_mov_b32 s35, 0x00020000
    s_mov_b32 exec_lo, 0xffffffff
    s_mov_b32 exec_hi, 0x0
    buffer_load_dword v1, v15, s[32:35], s58 offen
    s_mov_b64 exec, -1
    s_add_u32 s53, s57, 128
    s_add_u32 m0, s56, 49152
    s_nop 0
    buffer_load_dwordx4 v11, s[20:23], s53 offen lds
    s_add_u32 m0, s56, 53248
    s_nop 0
    buffer_load_dwordx4 v12, s[20:23], s53 offen lds
    s_add_u32 s53, s58, 229376
    s_add_u32 m0, s56, 131072
    s_nop 0
    buffer_load_dwordx4 v13, s[24:27], s53 offen lds
    s_add_u32 m0, s56, 139264
    s_nop 0
    buffer_load_dwordx4 v13, s[28:31], s53 offen lds
    s_add_u32 m0, s56, 135168
    s_nop 0
    buffer_load_dwordx4 v14, s[24:27], s53 offen lds
    s_add_u32 m0, s56, 143360
    s_nop 0
    buffer_load_dwordx4 v14, s[28:31], s53 offen lds
    s_add_u32 s53, s57, 131200
    s_add_u32 m0, s56, 57344
    s_nop 0
    buffer_load_dwordx4 v11, s[20:23], s53 offen lds
    s_add_u32 m0, s56, 61440
    s_nop 0
    buffer_load_dwordx4 v12, s[20:23], s53 offen lds
    s_add_u32 s53, s58, 458752
    s_add_u32 m0, s56, 147456
    s_nop 0
    buffer_load_dwordx4 v13, s[24:27], s53 offen lds
    s_add_u32 m0, s56, 155648
    s_nop 0
    buffer_load_dwordx4 v13, s[28:31], s53 offen lds
    s_add_u32 m0, s56, 151552
    s_nop 0
    buffer_load_dwordx4 v14, s[24:27], s53 offen lds
    s_add_u32 m0, s56, 159744
    s_nop 0
    buffer_load_dwordx4 v14, s[28:31], s53 offen lds
    s_add_u32 s53, s57, 256
    s_add_u32 m0, s56, 0
    s_nop 0
    buffer_load_dwordx4 v11, s[20:23], s53 offen lds
    s_add_u32 m0, s56, 4096
    s_nop 0
    buffer_load_dwordx4 v12, s[20:23], s53 offen lds
    s_add_u32 s53, s58, 688128
    s_add_u32 m0, s56, 65536
    s_nop 0
    buffer_load_dwordx4 v13, s[24:27], s53 offen lds
    s_add_u32 m0, s56, 73728
    s_nop 0
    buffer_load_dwordx4 v13, s[28:31], s53 offen lds
    s_add_u32 m0, s56, 69632
    s_nop 0
    buffer_load_dwordx4 v14, s[24:27], s53 offen lds
    s_add_u32 m0, s56, 77824
    s_nop 0
    buffer_load_dwordx4 v14, s[28:31], s53 offen lds
    s_add_u32 s53, s57, 131328
    s_add_u32 m0, s56, 8192
    s_nop 0
    buffer_load_dwordx4 v11, s[20:23], s53 offen lds
    s_add_u32 m0, s56, 12288
    s_nop 0
    buffer_load_dwordx4 v12, s[20:23], s53 offen lds
    s_add_u32 s53, s58, 917504
    s_add_u32 m0, s56, 81920
    s_nop 0
    buffer_load_dwordx4 v13, s[24:27], s53 offen lds
    s_add_u32 m0, s56, 90112
    s_nop 0
    buffer_load_dwordx4 v13, s[28:31], s53 offen lds
    s_add_u32 m0, s56, 86016
    s_nop 0
    buffer_load_dwordx4 v14, s[24:27], s53 offen lds
    s_add_u32 m0, s56, 94208
    s_nop 0
    buffer_load_dwordx4 v14, s[28:31], s53 offen lds
    s_mov_b32 s32, s10
    s_and_b32 s33, s11, 0xffff
    s_mov_b32 s34, 7340032
    s_mov_b32 s35, 0x00020000
    s_mov_b32 s36, s16
    s_and_b32 s37, s17, 0xffff
    s_mov_b32 s38, 268435456
    s_mov_b32 s39, 0x00020000
    s_mov_b32 s40, s12
    s_and_b32 s41, s13, 0xffff
    s_mov_b32 s42, 2097152
    s_mov_b32 s43, 0x00020000
    s_mov_b32 s44, s14
    s_and_b32 s45, s15, 0xffff
    s_mov_b32 s46, 256
    s_mov_b32 s47, 0x00020000
    s_lshl_b32 s60, s48, 10
    s_and_b32 s60, s60, 3072
    v_lshlrev_b32 v7, 4, v2
    v_mov_b32 v10, 0
    v_lshrrev_b32 v3, 3, v2
    v_and_b32 v4, 6, v3
    v_lshlrev_b32 v3, 11, v3
    v_and_b32 v5, 7, v2
    v_xor_b32 v4, v4, v5
    v_lshl_add_u32 v3, v4, 4, v3
    s_and_b32 s53, s48, 2
    s_lshl_b32 s53, s53, 16
    s_and_b32 s54, s48, 1
    s_lshl_b32 s54, s54, 7
    s_add_u32 s53, s53, s54
    v_add_u32 v6, s53, v3
    s_mul_i32 s54, s59, 1835008
    s_lshl_b32 s53, s50, 8
    s_add_u32 s54, s54, s53
    s_mul_i32 s7, s49, 954368
    s_mul_i32 s53, s59, 28672
    s_add_u32 s7, s7, s53
    s_add_u32 s7, s7, s60
    s_add_u32 s7, s7, 65536
    s_mov_b32 s3, s7
    s_and_b32 s53, s50, 3
    s_mul_i32 s53, s53, 0
    s_add_u32 s53, s53, s49
    s_sub_u32 s8, s53, 7
    s_cselect_b32 s53, s53, s8
    s_lshl_b32 s8, s53, 18
    s_add_u32 s64, s54, s8
    s_mul_i32 s8, s53, 4096
    s_add_u32 s71, s8, s7
    s_add_u32 s53, s53, 1
    s_cmp_eq_u32 s53, 7
    s_cselect_b32 s53, 0, s53
    s_lshl_b32 s8, s53, 18
    s_add_u32 s65, s54, s8
    s_mul_i32 s8, s53, 4096
    s_add_u32 s72, s8, s7
    s_add_u32 s53, s53, 1
    s_cmp_eq_u32 s53, 7
    s_cselect_b32 s53, 0, s53
    s_lshl_b32 s8, s53, 18
    s_add_u32 s66, s54, s8
    s_mul_i32 s8, s53, 4096
    s_add_u32 s73, s8, s7
    s_add_u32 s53, s53, 1
    s_cmp_eq_u32 s53, 7
    s_cselect_b32 s53, 0, s53
    s_lshl_b32 s8, s53, 18
    s_add_u32 s67, s54, s8
    s_mul_i32 s8, s53, 4096
    s_add_u32 s74, s8, s7
    s_add_u32 s53, s53, 1
    s_cmp_eq_u32 s53, 7
    s_cselect_b32 s53, 0, s53
    s_lshl_b32 s8, s53, 18
    s_add_u32 s68, s54, s8
    s_mul_i32 s8, s53, 4096
    s_add_u32 s75, s8, s7
    s_add_u32 s53, s53, 1
    s_cmp_eq_u32 s53, 7
    s_cselect_b32 s53, 0, s53
    s_lshl_b32 s8, s53, 18
    s_add_u32 s69, s54, s8
    s_mul_i32 s8, s53, 4096
    s_add_u32 s76, s8, s7
    s_add_u32 s53, s53, 1
    s_cmp_eq_u32 s53, 7
    s_cselect_b32 s53, 0, s53
    s_lshl_b32 s8, s53, 18
    s_add_u32 s70, s54, s8
    s_mul_i32 s8, s53, 4096
    s_add_u32 s77, s8, s7
    s_movk_i32 s11, 0xff
    s_lshl_b32 s53, s49, 2
    s_add_u32 s53, s53, s59
    s_lshl_b32 s53, s53, 9
    s_and_b32 s54, s48, 2
    s_lshl_b32 s54, s54, 7
    s_add_u32 s53, s53, s54
    s_add_u32 s14, s53, 14680064
    v_lshlrev_b32 v3, 2, v2
    v_add_u32 v9, s14, v3
    s_lshl_b32 s7, s49, 3
    s_add_u32 s7, s7, s50
    s_mul_i32 s7, s7, 196608
    s_lshl_b32 s54, s60, 1
    s_add_u32 s7, s7, s54
    s_add_u32 s7, s7, 16777216
    s_add_u32 s53, s59, 1
    s_and_b32 s53, s53, 3
    s_mul_i32 s53, s53, 49152
    s_add_u32 s53, s53, 0
    s_add_u32 s4, s53, s7
    s_add_u32 s53, s59, 2
    s_and_b32 s53, s53, 3
    s_mul_i32 s53, s53, 49152
    s_add_u32 s53, s53, 16384
    s_add_u32 s5, s53, s7
    s_add_u32 s53, s59, 3
    s_and_b32 s53, s53, 3
    s_mul_i32 s53, s53, 49152
    s_add_u32 s53, s53, 32768
    s_add_u32 s6, s53, s7
    s_mul_i32 s54, s59, 49152
    s_add_u32 s7, s7, s54
    s_lshl_b32 s53, s49, 3
    s_add_u32 s53, s53, s59
    s_lshl_b32 s8, s53, 15
    s_lshl_b32 s53, s50, 8
    s_add_u32 s8, s8, s53
    s_and_b32 s53, s48, 1
    s_lshl_b32 s53, s53, 7
    s_add_u32 s8, s8, s53
    s_and_b32 s53, s48, 2
    s_lshl_b32 s53, s53, 5
    s_add_u32 s8, s8, s53
    s_and_b32 s53, s48, 1
    s_mul_i32 s54, s52, 932
    s_mul_i32 s18, s53, 464
    s_add_u32 s18, s18, s54
    s_mul_i32 s54, s51, 4
    s_add_u32 s18, s18, s54
    s_and_b32 s54, s48, 2
    s_add_u32 s18, s18, s54
    s_lshl_b32 s18, s18, 10
    s_add_u32 s18, s18, 65536
    s_lshl_b32 s54, s54, 7
    s_lshl_b32 s53, s53, 2
    s_add_u32 s19, s53, s54
    s_lshl_b32 s53, s52, 2
    s_add_u32 s53, s53, s59
    s_lshl_b32 s53, s53, 9
    s_add_u32 s19, s19, s53
    s_mul_i32 s53, s59, 7
    s_sub_u32 s53, s51, s53
    s_lshl_b32 s53, s53, 3
    s_add_u32 s19, s19, s53
    s_add_u32 s19, s19, 14680064
    s_lshr_b32 s53, s60, 2
    s_add_u32 s53, s53, 45056
    v_lshlrev_b32 v15, 2, v2
    v_add_u32 v15, s53, v15
    v_lshrrev_b32 v3, 5, v2
    v_lshlrev_b32 v3, 12, v3
    v_bfe_u32 v4, v2, 2, 3
    v_lshl_add_u32 v3, v4, 7, v3
    v_and_b32 v5, 3, v2
    v_lshl_add_u32 v3, v5, 3, v3
    s_add_u32 s53, s60, 32768
    v_add_u32 v3, s53, v3
    v_lshrrev_b32 v4, 1, v4
    v_xor_b32 v5, 0, v4
    v_lshl_add_u32 v227, v5, 5, v3
    v_add_u32 v226, 0x10000, v227
    v_xor_b32 v5, 1, v4
    v_lshl_add_u32 v231, v5, 5, v3
    v_add_u32 v230, 0x10000, v231
    v_xor_b32 v5, 2, v4
    v_lshl_add_u32 v235, v5, 5, v3
    v_add_u32 v234, 0x10000, v235
    v_xor_b32 v5, 3, v4
    v_lshl_add_u32 v239, v5, 5, v3
    v_add_u32 v238, 0x10000, v239
    v_and_b32 v244, 3, v2
    v_lshlrev_b32 v244, 6, v244
    v_add_u32 v244, v244, v2
    v_lshlrev_b32 v244, 2, v244
    v_add_u32 v244, 45056, v244
    s_waitcnt vmcnt(25)
    s_barrier
    s_add_u32 s53, s57, 384
    s_add_u32 m0, s56, 16384
    s_nop 0
    buffer_load_dwordx4 v11, s[20:23], s53 offen lds
    s_add_u32 m0, s56, 20480
    s_nop 0
    buffer_load_dwordx4 v12, s[20:23], s53 offen lds
    s_add_u32 s53, s58, 1146880
    s_add_u32 m0, s56, 98304
    s_nop 0
    buffer_load_dwordx4 v13, s[24:27], s53 offen lds
    s_add_u32 m0, s56, 106496
    s_nop 0
    buffer_load_dwordx4 v13, s[28:31], s53 offen lds
    s_add_u32 m0, s56, 102400
    s_nop 0
    buffer_load_dwordx4 v14, s[24:27], s53 offen lds
    s_add_u32 m0, s56, 110592
    s_nop 0
    buffer_load_dwordx4 v14, s[28:31], s53 offen lds
    s_waitcnt vmcnt(24)
    s_barrier
    s_add_u32 s53, s57, 131456
    s_add_u32 m0, s56, 24576
    s_nop 0
    buffer_load_dwordx4 v11, s[20:23], s53 offen lds
    s_add_u32 m0, s56, 28672
    s_nop 0
    buffer_load_dwordx4 v12, s[20:23], s53 offen lds
    s_add_u32 s53, s58, 1376256
    s_add_u32 m0, s56, 114688
    s_nop 0
    buffer_load_dwordx4 v13, s[24:27], s53 offen lds
    s_add_u32 m0, s56, 122880
    s_nop 0
    buffer_load_dwordx4 v13, s[28:31], s53 offen lds
    s_add_u32 m0, s56, 118784
    s_nop 0
    buffer_load_dwordx4 v14, s[24:27], s53 offen lds
    s_add_u32 m0, s56, 126976
    s_nop 0
    buffer_load_dwordx4 v14, s[28:31], s53 offen lds
    s_waitcnt vmcnt(24)
    s_barrier
    s_add_u32 s53, s57, 512
    s_add_u32 m0, s56, 32768
    s_nop 0
    buffer_load_dwordx4 v11, s[20:23], s53 offen lds
    s_add_u32 m0, s56, 36864
    s_nop 0
    buffer_load_dwordx4 v12, s[20:23], s53 offen lds
    s_add_u32 s53, s58, 1605632
    s_add_u32 m0, s56, 131072
    s_nop 0
    buffer_load_dwordx4 v13, s[24:27], s53 offen lds
    s_add_u32 m0, s56, 139264
    s_nop 0
    buffer_load_dwordx4 v13, s[28:31], s53 offen lds
    s_add_u32 m0, s56, 135168
    s_nop 0
    buffer_load_dwordx4 v14, s[24:27], s53 offen lds
    s_add_u32 m0, s56, 143360
    s_nop 0
    buffer_load_dwordx4 v14, s[28:31], s53 offen lds
    s_waitcnt vmcnt(24)
    s_barrier
    s_add_u32 s53, s57, 131584
    s_add_u32 m0, s56, 40960
    s_nop 0
    buffer_load_dwordx4 v11, s[20:23], s53 offen lds
    s_add_u32 m0, s56, 45056
    s_nop 0
    buffer_load_dwordx4 v12, s[20:23], s53 offen lds
    s_add_u32 s53, s58, 1835008
    s_add_u32 m0, s56, 147456
    s_nop 0
    buffer_load_dwordx4 v13, s[24:27], s53 offen lds
    s_add_u32 m0, s56, 155648
    s_nop 0
    buffer_load_dwordx4 v13, s[28:31], s53 offen lds
    s_add_u32 m0, s56, 151552
    s_nop 0
    buffer_load_dwordx4 v14, s[24:27], s53 offen lds
    s_add_u32 m0, s56, 159744
    s_nop 0
    buffer_load_dwordx4 v14, s[28:31], s53 offen lds
    v_mov_b32 v240, -1
    v_mov_b32 v241, -1
    v_mov_b32 v242, -1
    v_mov_b32 v243, -1
    s_add_u32 s53, s18, 0
    buffer_store_dwordx4 v[240:243], v7, s[36:39], s53 offen offset:0 sc1
    s_mov_b64 exec, 0
    s_and_b32 s53, s48, 3
    s_cmp_eq_u32 s53, 0
    s_cbranch_scc1 L_PAD_p2h.1
    s_cmp_eq_u32 s53, 1
    s_cbranch_scc1 L_PAD_p2h.2
    s_cmp_eq_u32 s53, 2
    s_cbranch_scc1 L_PAD_p2h.3
    s_cmp_eq_u32 s53, 3
    s_cbranch_scc1 L_PAD_tail.9
L_RETL4:
    s_mov_b64 exec, -1
    s_waitcnt vmcnt(25)
    s_barrier
    s_add_u32 s53, s57, 640
    s_add_u32 m0, s56, 49152
    s_nop 0
    buffer_load_dwordx4 v11, s[20:23], s53 offen lds
    s_add_u32 m0, s56, 53248
    s_nop 0
    buffer_load_dwordx4 v12, s[20:23], s53 offen lds
    s_add_u32 s53, s58, 2064384
    s_add_u32 m0, s56, 65536
    s_nop 0
    buffer_load_dwordx4 v13, s[24:27], s53 offen lds
    s_add_u32 m0, s56, 73728
    s_nop 0
    buffer_load_dwordx4 v13, s[28:31], s53 offen lds
    s_add_u32 m0, s56, 69632
    s_nop 0
    buffer_load_dwordx4 v14, s[24:27], s53 offen lds
    s_add_u32 m0, s56, 77824
    s_nop 0
    buffer_load_dwordx4 v14, s[28:31], s53 offen lds
    s_waitcnt vmcnt(25)
    s_barrier
    s_add_u32 s53, s57, 131712
    s_add_u32 m0, s56, 57344
    s_nop 0
    buffer_load_dwordx4 v11, s[20:23], s53 offen lds
    s_add_u32 m0, s56, 61440
    s_nop 0
    buffer_load_dwordx4 v12, s[20:23], s53 offen lds
    s_add_u32 s53, s58, 2293760
    s_add_u32 m0, s56, 81920
    s_nop 0
    buffer_load_dwordx4 v13, s[24:27], s53 offen lds
    s_add_u32 m0, s56, 90112
    s_nop 0
    buffer_load_dwordx4 v13, s[28:31], s53 offen lds
    s_add_u32 m0, s56, 86016
    s_nop 0
    buffer_load_dwordx4 v14, s[24:27], s53 offen lds
    s_add_u32 m0, s56, 94208
    s_nop 0
    buffer_load_dwordx4 v14, s[28:31], s53 offen lds
    s_add_u32 s53, s18, 0
    buffer_store_dwordx4 v[240:243], v7, s[36:39], s53 offen offset:1024 sc1
    s_waitcnt vmcnt(26)
    s_barrier
    s_add_u32 s53, s57, 768
    s_add_u32 m0, s56, 0
    s_nop 0
    buffer_load_dwordx4 v11, s[20:23], s53 offen lds
    s_add_u32 m0, s56, 4096
    s_nop 0
    buffer_load_dwordx4 v12, s[20:23], s53 offen lds
    s_add_u32 s53, s58, 2523136
    s_add_u32 m0, s56, 98304
    s_nop 0
    buffer_load_dwordx4 v13, s[24:27], s53 offen lds
    s_add_u32 m0, s56, 106496
    s_nop 0
    buffer_load_dwordx4 v13, s[28:31], s53 offen lds
    s_add_u32 m0, s56, 102400
    s_nop 0
    buffer_load_dwordx4 v14, s[24:27], s53 offen lds
    s_add_u32 m0, s56, 110592
    s_nop 0
    buffer_load_dwordx4 v14, s[28:31], s53 offen lds
    s_waitcnt vmcnt(26)
    s_barrier
    s_add_u32 s53, s57, 131840
    s_add_u32 m0, s56, 8192
    s_nop 0
    buffer_load_dwordx4 v11, s[20:23], s53 offen lds
    s_add_u32 m0, s56, 12288
    s_nop 0
    buffer_load_dwordx4 v12, s[20:23], s53 offen lds
    s_add_u32 s53, s58, 2752512
    s_add_u32 m0, s56, 114688
    s_nop 0
    buffer_load_dwordx4 v13, s[24:27], s53 offen lds
    s_add_u32 m0, s56, 122880
    s_nop 0
    buffer_load_dwordx4 v13, s[28:31], s53 offen lds
    s_add_u32 m0, s56, 118784
    s_nop 0
    buffer_load_dwordx4 v14, s[24:27], s53 offen lds
    s_add_u32 m0, s56, 126976
    s_nop 0
    buffer_load_dwordx4 v14, s[28:31], s53 offen lds
    s_add_u32 s53, s18, 118784
    buffer_store_dwordx4 v[240:243], v7, s[36:39], s53 offen offset:0 sc1
    s_waitcnt vmcnt(27)
    s_barrier
    s_add_u32 s53, s57, 896
    s_add_u32 m0, s56, 16384
    s_nop 0
    buffer_load_dwordx4 v11, s[20:23], s53 offen lds
    s_add_u32 m0, s56, 20480
    s_nop 0
    buffer_load_dwordx4 v12, s[20:23], s53 offen lds
    s_add_u32 s53, s58, 2981888
    s_add_u32 m0, s56, 131072
    s_nop 0
    buffer_load_dwordx4 v13, s[24:27], s53 offen lds
    s_add_u32 m0, s56, 139264
    s_nop 0
    buffer_load_dwordx4 v13, s[28:31], s53 offen lds
    s_add_u32 m0, s56, 135168
    s_nop 0
    buffer_load_dwordx4 v14, s[24:27], s53 offen lds
    s_add_u32 m0, s56, 143360
    s_nop 0
    buffer_load_dwordx4 v14, s[28:31], s53 offen lds
    buffer_load_dword v8, v10, s[44:47], 0 offen sc1
    s_waitcnt vmcnt(27)
    s_barrier
    s_add_u32 s53, s57, 131968
    s_add_u32 m0, s56, 24576
    s_nop 0
    buffer_load_dwordx4 v11, s[20:23], s53 offen lds
    s_add_u32 m0, s56, 28672
    s_nop 0
    buffer_load_dwordx4 v12, s[20:23], s53 offen lds
    s_add_u32 s53, s58, 3211264
    s_add_u32 m0, s56, 147456
    s_nop 0
    buffer_load_dwordx4 v13, s[24:27], s53 offen lds
    s_add_u32 m0, s56, 155648
    s_nop 0
    buffer_load_dwordx4 v13, s[28:31], s53 offen lds
    s_add_u32 m0, s56, 151552
    s_nop 0
    buffer_load_dwordx4 v14, s[24:27], s53 offen lds
    s_add_u32 m0, s56, 159744
    s_nop 0
    buffer_load_dwordx4 v14, s[28:31], s53 offen lds
    s_add_u32 s53, s18, 118784
    buffer_store_dwordx4 v[240:243], v7, s[36:39], s53 offen offset:1024 sc1
    s_waitcnt vmcnt(28)
    s_barrier
    s_add_u32 s53, s57, 1024
    s_add_u32 m0, s56, 32768
    s_nop 0
    buffer_load_dwordx4 v11, s[20:23], s53 offen lds
    s_add_u32 m0, s56, 36864
    s_nop 0
    buffer_load_dwordx4 v12, s[20:23], s53 offen lds
    s_add_u32 s53, s58, 3440640
    s_add_u32 m0, s56, 65536
    s_nop 0
    buffer_load_dwordx4 v13, s[24:27], s53 offen lds
    s_add_u32 m0, s56, 73728
    s_nop 0
    buffer_load_dwordx4 v13, s[28:31], s53 offen lds
    s_add_u32 m0, s56, 69632
    s_nop 0
    buffer_load_dwordx4 v14, s[24:27], s53 offen lds
    s_add_u32 m0, s56, 77824
    s_nop 0
    buffer_load_dwordx4 v14, s[28:31], s53 offen lds
    s_waitcnt vmcnt(27)
    s_barrier
    s_add_u32 s53, s57, 132096
    s_add_u32 m0, s56, 40960
    s_nop 0
    buffer_load_dwordx4 v11, s[20:23], s53 offen lds
    s_add_u32 m0, s56, 45056
    s_nop 0
    buffer_load_dwordx4 v12, s[20:23], s53 offen lds
    s_add_u32 s53, s58, 3670016
    s_add_u32 m0, s56, 81920
    s_nop 0
    buffer_load_dwordx4 v13, s[24:27], s53 offen lds
    s_add_u32 m0, s56, 90112
    s_nop 0
    buffer_load_dwordx4 v13, s[28:31], s53 offen lds
    s_add_u32 m0, s56, 86016
    s_nop 0
L_PAD_ent.4:
    s_cbranch_execz L_DISP
    buffer_load_dwordx4 v14, s[24:27], s53 offen lds
    s_add_u32 m0, s56, 94208
    s_nop 0
    buffer_load_dwordx4 v14, s[28:31], s53 offen lds
    s_add_u32 s53, s18, 237568
    buffer_store_dwordx4 v[240:243], v7, s[36:39], s53 offen offset:0 sc1
    s_waitcnt vmcnt(28)
    s_barrier
    s_add_u32 s53, s57, 1152
    s_add_u32 m0, s56, 49152
    s_nop 0
    buffer_load_dwordx4 v11, s[20:23], s53 offen lds
    s_add_u32 m0, s56, 53248
    s_nop 0
    buffer_load_dwordx4 v12, s[20:23], s53 offen lds
    s_add_u32 s53, s58, 3899392
    s_add_u32 m0, s56, 98304
    s_nop 0
    buffer_load_dwordx4 v13, s[24:27], s53 offen lds
    s_add_u32 m0, s56, 106496
    s_nop 0
    buffer_load_dwordx4 v13, s[28:31], s53 offen lds
    s_add_u32 m0, s56, 102400
    s_nop 0
    buffer_load_dwordx4 v14, s[24:27], s53 offen lds
    s_add_u32 m0, s56, 110592
    s_nop 0
    buffer_load_dwordx4 v14, s[28:31], s53 offen lds
    s_waitcnt vmcnt(27)
    s_barrier
    s_add_u32 s53, s57, 132224
    s_add_u32 m0, s56, 57344
    s_nop 0
    buffer_load_dwordx4 v11, s[20:23], s53 offen lds
    s_add_u32 m0, s56, 61440
    s_nop 0
    buffer_load_dwordx4 v12, s[20:23], s53 offen lds
    s_add_u32 s53, s58, 4128768
    s_add_u32 m0, s56, 114688
    s_nop 0
    buffer_load_dwordx4 v13, s[24:27], s53 offen lds
    s_add_u32 m0, s56, 122880
    s_nop 0
    buffer_load_dwordx4 v13, s[28:31], s53 offen lds
    s_add_u32 m0, s56, 118784
    s_nop 0
    buffer_load_dwordx4 v14, s[24:27], s53 offen lds
    s_add_u32 m0, s56, 126976
    s_nop 0
    buffer_load_dwordx4 v14, s[28:31], s53 offen lds
    s_add_u32 s53, s18, 237568
    buffer_store_dwordx4 v[240:243], v7, s[36:39], s53 offen offset:1024 sc1
    s_waitcnt vmcnt(27)
    s_barrier
    s_add_u32 s53, s57, 1280
    s_add_u32 m0, s56, 0
    s_nop 0
    buffer_load_dwordx4 v11, s[20:23], s53 offen lds
    s_add_u32 m0, s56, 4096
    s_nop 0
    buffer_load_dwordx4 v12, s[20:23], s53 offen lds
    s_add_u32 s53, s58, 4358144
    s_add_u32 m0, s56, 131072
    s_nop 0
    buffer_load_dwordx4 v13, s[24:27], s53 offen lds
    s_add_u32 m0, s56, 139264
    s_nop 0
    buffer_load_dwordx4 v13, s[28:31], s53 offen lds
    s_add_u32 m0, s56, 135168
    s_nop 0
    buffer_load_dwordx4 v14, s[24:27], s53 offen lds
    s_add_u32 m0, s56, 143360
    s_nop 0
    buffer_load_dwordx4 v14, s[28:31], s53 offen lds
    s_waitcnt vmcnt(26)
    s_barrier
    s_add_u32 s53, s57, 132352
    s_add_u32 m0, s56, 8192
    s_nop 0
    buffer_load_dwordx4 v11, s[20:23], s53 offen lds
    s_add_u32 m0, s56, 12288
    s_nop 0
    buffer_load_dwordx4 v12, s[20:23], s53 offen lds
    s_add_u32 s53, s58, 4587520
    s_add_u32 m0, s56, 147456
    s_nop 0
    buffer_load_dwordx4 v13, s[24:27], s53 offen lds
    s_add_u32 m0, s56, 155648
    s_nop 0
    buffer_load_dwordx4 v13, s[28:31], s53 offen lds
    s_add_u32 m0, s56, 151552
    s_nop 0
    buffer_load_dwordx4 v14, s[24:27], s53 offen lds
    s_add_u32 m0, s56, 159744
    s_nop 0
    buffer_load_dwordx4 v14, s[28:31], s53 offen lds
    s_add_u32 s53, s18, 356352
    buffer_store_dwordx4 v[240:243], v7, s[36:39], s53 offen offset:0 sc1
    s_waitcnt vmcnt(27)
    s_barrier
    s_add_u32 s53, s57, 1408
    s_add_u32 m0, s56, 16384
    s_nop 0
    buffer_load_dwordx4 v11, s[20:23], s53 offen lds
    s_add_u32 m0, s56, 20480
    s_nop 0
    buffer_load_dwordx4 v12, s[20:23], s53 offen lds
    s_add_u32 s53, s58, 4816896
    s_add_u32 m0, s56, 65536
    s_nop 0
    buffer_load_dwordx4 v13, s[24:27], s53 offen lds
    s_add_u32 m0, s56, 73728
    s_nop 0
    buffer_load_dwordx4 v13, s[28:31], s53 offen lds
    s_add_u32 m0, s56, 69632
    s_nop 0
    buffer_load_dwordx4 v14, s[24:27], s53 offen lds
    s_add_u32 m0, s56, 77824
    s_nop 0
    buffer_load_dwordx4 v14, s[28:31], s53 offen lds
    s_waitcnt vmcnt(26)
    s_barrier
    s_add_u32 s53, s57, 132480
    s_add_u32 m0, s56, 24576
    s_nop 0
    buffer_load_dwordx4 v11, s[20:23], s53 offen lds
    s_add_u32 m0, s56, 28672
    s_nop 0
    buffer_load_dwordx4 v12, s[20:23], s53 offen lds
    s_add_u32 s53, s58, 5046272
    s_add_u32 m0, s56, 81920
    s_nop 0
    buffer_load_dwordx4 v13, s[24:27], s53 offen lds
    s_add_u32 m0, s56, 90112
    s_nop 0
    buffer_load_dwordx4 v13, s[28:31], s53 offen lds
    s_add_u32 m0, s56, 86016
    s_nop 0
    buffer_load_dwordx4 v14, s[24:27], s53 offen lds
    s_add_u32 m0, s56, 94208
    s_nop 0
    buffer_load_dwordx4 v14, s[28:31], s53 offen lds
    s_add_u32 s53, s18, 356352
    buffer_store_dwordx4 v[240:243], v7, s[36:39], s53 offen offset:1024 sc1
    s_waitcnt vmcnt(27)
    s_barrier
    s_add_u32 s53, s57, 1536
    s_add_u32 m0, s56, 32768
    s_nop 0
    buffer_load_dwordx4 v11, s[20:23], s53 offen lds
    s_add_u32 m0, s56, 36864
    s_nop 0
    buffer_load_dwordx4 v12, s[20:23], s53 offen lds
    s_add_u32 s53, s58, 5275648
    s_add_u32 m0, s56, 98304
    s_nop 0
    buffer_load_dwordx4 v13, s[24:27], s53 offen lds
    s_add_u32 m0, s56, 106496
    s_nop 0
    buffer_load_dwordx4 v13, s[28:31], s53 offen lds
    s_add_u32 m0, s56, 102400
    s_nop 0
    buffer_load_dwordx4 v14, s[24:27], s53 offen lds
    s_add_u32 m0, s56, 110592
    s_nop 0
    buffer_load_dwordx4 v14, s[28:31], s53 offen lds
    s_waitcnt vmcnt(26)
    s_barrier
    s_add_u32 s53, s57, 132608
    s_add_u32 m0, s56, 40960
    s_nop 0
    buffer_load_dwordx4 v11, s[20:23], s53 offen lds
    s_add_u32 m0, s56, 45056
    s_nop 0
    buffer_load_dwordx4 v12, s[20:23], s53 offen lds
    s_add_u32 s53, s58, 5505024
    s_add_u32 m0, s56, 114688
    s_nop 0
    buffer_load_dwordx4 v13, s[24:27], s53 offen lds
    s_add_u32 m0, s56, 122880
    s_nop 0
    buffer_load_dwordx4 v13, s[28:31], s53 offen lds
    s_add_u32 m0, s56, 118784
    s_nop 0
    buffer_load_dwordx4 v14, s[24:27], s53 offen lds
    s_add_u32 m0, s56, 126976
    s_nop 0
    buffer_load_dwordx4 v14, s[28:31], s53 offen lds
    s_waitcnt vmcnt(26)
    s_barrier
    s_add_u32 s53, s57, 1664
    s_add_u32 m0, s56, 49152
    s_nop 0
    buffer_load_dwordx4 v11, s[20:23], s53 offen lds
    s_add_u32 m0, s56, 53248
    s_nop 0
    buffer_load_dwordx4 v12, s[20:23], s53 offen lds
    s_add_u32 s53, s58, 5734400
    s_add_u32 m0, s56, 131072
    s_nop 0
    buffer_load_dwordx4 v13, s[24:27], s53 offen lds
    s_add_u32 m0, s56, 139264
    s_nop 0
    buffer_load_dwordx4 v13, s[28:31], s53 offen lds
    s_add_u32 m0, s56, 135168
    s_nop 0
    buffer_load_dwordx4 v14, s[24:27], s53 offen lds
    s_add_u32 m0, s56, 143360
    s_nop 0
    buffer_load_dwordx4 v14, s[28:31], s53 offen lds
    s_waitcnt vmcnt(25)
    s_barrier
    s_add_u32 s53, s57, 132736
    s_add_u32 m0, s56, 57344
    s_nop 0
    buffer_load_dwordx4 v11, s[20:23], s53 offen lds
    s_add_u32 m0, s56, 61440
    s_nop 0
    buffer_load_dwordx4 v12, s[20:23], s53 offen lds
    s_add_u32 s53, s58, 5963776
    s_add_u32 m0, s56, 147456
    s_nop 0
    buffer_load_dwordx4 v13, s[24:27], s53 offen lds
    s_add_u32 m0, s56, 155648
    s_nop 0
    buffer_load_dwordx4 v13, s[28:31], s53 offen lds
    s_add_u32 m0, s56, 151552
    s_nop 0
    buffer_load_dwordx4 v14, s[24:27], s53 offen lds
    s_add_u32 m0, s56, 159744
    s_nop 0
    buffer_load_dwordx4 v14, s[28:31], s53 offen lds
    s_waitcnt vmcnt(24)
    v_readfirstlane_b32 s61, v8
    s_mov_b32 s62, 0x40000
LD_TL:
    s_cmp_lg_u32 s61, 0
    s_cbranch_scc1 LD_TOK
    s_sub_u32 s62, s62, 1
    s_cbranch_scc1 LD_TOK
    buffer_load_dword v8, v10, s[44:47], 0 offen sc1
    s_waitcnt vmcnt(0)
    v_readfirstlane_b32 s61, v8
    s_branch LD_TL
LD_TOK:
    v_mov_b32 v3, s61
    s_mov_b64 exec, 1
    buffer_store_dword v3, v10, s[36:39], s19 offen offset:128 sc1
    s_mov_b64 exec, -1
    s_barrier
    s_add_u32 s53, s57, 1792
    s_add_u32 m0, s56, 0
    s_nop 0
    buffer_load_dwordx4 v11, s[20:23], s53 offen lds
    s_add_u32 m0, s56, 4096
    s_nop 0
    buffer_load_dwordx4 v12, s[20:23], s53 offen lds
    s_add_u32 s53, s58, 6193152
    s_add_u32 m0, s56, 65536
    s_nop 0
    buffer_load_dwordx4 v13, s[24:27], s53 offen lds
    s_add_u32 m0, s56, 73728
    s_nop 0
    buffer_load_dwordx4 v13, s[28:31], s53 offen lds
    s_add_u32 m0, s56, 69632
    s_nop 0
    buffer_load_dwordx4 v14, s[24:27], s53 offen lds
    s_add_u32 m0, s56, 77824
    s_nop 0
    buffer_load_dwordx4 v14, s[28:31], s53 offen lds
    s_waitcnt vmcnt(25)
    s_barrier
    s_add_u32 s53, s57, 132864
    s_add_u32 m0, s56, 8192
    s_nop 0
    buffer_load_dwordx4 v11, s[20:23], s53 offen lds
    s_add_u32 m0, s56, 12288
    s_nop 0
    buffer_load_dwordx4 v12, s[20:23], s53 offen lds
    s_add_u32 s53, s58, 6422528
    s_add_u32 m0, s56, 81920
    s_nop 0
    buffer_load_dwordx4 v13, s[24:27], s53 offen lds
    s_add_u32 m0, s56, 90112
    s_nop 0
    buffer_load_dwordx4 v13, s[28:31], s53 offen lds
    s_add_u32 m0, s56, 86016
    s_nop 0
    buffer_load_dwordx4 v14, s[24:27], s53 offen lds
    s_add_u32 m0, s56, 94208
    s_nop 0
    buffer_load_dwordx4 v14, s[28:31], s53 offen lds
    s_waitcnt vmcnt(25)
    s_barrier
    s_add_u32 s53, s57, 1920
    s_add_u32 m0, s56, 16384
    s_nop 0
    buffer_load_dwordx4 v11, s[20:23], s53 offen lds
    s_add_u32 m0, s56, 20480
    s_nop 0
    buffer_load_dwordx4 v12, s[20:23], s53 offen lds
    s_add_u32 s53, s58, 6651904
    s_add_u32 m0, s56, 98304
    s_nop 0
    buffer_load_dwordx4 v13, s[24:27], s53 offen lds
    s_add_u32 m0, s56, 106496
    s_nop 0
    buffer_load_dwordx4 v13, s[28:31], s53 offen lds
    s_add_u32 m0, s56, 102400
    s_nop 0
    buffer_load_dwordx4 v14, s[24:27], s53 offen lds
    s_add_u32 m0, s56, 110592
    s_nop 0
    buffer_load_dwordx4 v14, s[28:31], s53 offen lds
    s_waitcnt vmcnt(25)
    s_barrier
    s_add_u32 s53, s57, 132992
    s_add_u32 m0, s56, 24576
    s_nop 0
    buffer_load_dwordx4 v11, s[20:23], s53 offen lds
    s_add_u32 m0, s56, 28672
    s_nop 0
    buffer_load_dwordx4 v12, s[20:23], s53 offen lds
    s_add_u32 s53, s58, 6881280
    s_add_u32 m0, s56, 114688
    s_nop 0
    buffer_load_dwordx4 v13, s[24:27], s53 offen lds
    s_add_u32 m0, s56, 122880
    s_nop 0
    buffer_load_dwordx4 v13, s[28:31], s53 offen lds
    s_add_u32 m0, s56, 118784
    s_nop 0
    buffer_load_dwordx4 v14, s[24:27], s53 offen lds
    s_add_u32 m0, s56, 126976
    s_nop 0
    buffer_load_dwordx4 v14, s[28:31], s53 offen lds
    s_mov_b64 exec, 0x3fff
    buffer_load_dword v3, v9, s[36:39], 0 offen offset:128 sc1
    s_mov_b64 exec, -1
    s_waitcnt vmcnt(26)
    s_barrier
    s_add_u32 s53, s58, 7110656
    s_add_u32 m0, s56, 131072
    s_nop 0
    buffer_load_dwordx4 v13, s[24:27], s53 offen lds
    s_add_u32 m0, s56, 139264
    s_nop 0
    buffer_load_dwordx4 v13, s[28:31], s53 offen lds
    s_add_u32 m0, s56, 135168
    s_nop 0
    buffer_load_dwordx4 v14, s[24:27], s53 offen lds
    s_add_u32 m0, s56, 143360
    s_nop 0
    buffer_load_dwordx4 v14, s[28:31], s53 offen lds
    s_add_u32 m0, s60, 32768
    s_add_u32 s53, s64, 0
    buffer_load_dwordx4 v6, s[32:35], s53 offen lds
    s_add_u32 m0, s60, 36864
    s_add_u32 s53, s64, 16384
    buffer_load_dwordx4 v6, s[32:35], s53 offen lds
    s_waitcnt vmcnt(25)
    s_barrier
    ds_write_b32 v15, v10 offset:0
    ds_write_b32 v15, v10 offset:1024
    ds_write_b32 v15, v10 offset:2048
    ds_write_b32 v15, v10 offset:3072
    s_add_u32 m0, s60, 147456
    s_add_u32 s53, s64, 32768
    buffer_load_dwordx4 v6, s[32:35], s53 offen lds
    s_add_u32 m0, s60, 151552
    s_add_u32 s53, s64, 49152
    buffer_load_dwordx4 v6, s[32:35], s53 offen lds
    s_add_u32 m0, s60, 155648
    s_add_u32 s53, s64, 65536
    buffer_load_dwordx4 v6, s[32:35], s53 offen lds
    s_add_u32 m0, s60, 159744
    s_add_u32 s53, s64, 81920
    buffer_load_dwordx4 v6, s[32:35], s53 offen lds
    s_waitcnt vmcnt(11)
    s_waitcnt lgkmcnt(0)
    s_barrier
    s_add_u32 m0, s60, 49152
    s_add_u32 s53, s64, 98304
    buffer_load_dwordx4 v6, s[32:35], s53 offen lds
    s_add_u32 m0, s60, 53248
    s_add_u32 s53, s64, 114688
    buffer_load_dwordx4 v6, s[32:35], s53 offen lds
    s_add_u32 m0, s60, 57344
    s_add_u32 s53, s65, 0
    buffer_load_dwordx4 v6, s[32:35], s53 offen lds
    s_add_u32 m0, s60, 61440
    s_add_u32 s53, s65, 16384
    buffer_load_dwordx4 v6, s[32:35], s53 offen lds
    s_add_u32 m0, s60, 65536
    s_add_u32 s53, s65, 32768
    buffer_load_dwordx4 v6, s[32:35], s53 offen lds
    s_add_u32 m0, s60, 69632
    s_add_u32 s53, s65, 49152
    buffer_load_dwordx4 v6, s[32:35], s53 offen lds
    s_add_u32 m0, s60, 73728
    s_add_u32 s53, s65, 65536
    buffer_load_dwordx4 v6, s[32:35], s53 offen lds
    s_add_u32 m0, s60, 77824
    s_add_u32 s53, s65, 81920
    buffer_load_dwordx4 v6, s[32:35], s53 offen lds
    s_waitcnt vmcnt(12)
    ds_read_b64_tr_b16 v[16:17], v227 offset:0
    ds_read_b64_tr_b16 v[20:21], v231 offset:0
    ds_read_b64_tr_b16 v[24:25], v235 offset:0
    ds_read_b64_tr_b16 v[28:29], v239 offset:0
    s_waitcnt vmcnt(10)
    ds_read_b64_tr_b16 v[18:19], v226 offset:49152
    ds_read_b64_tr_b16 v[22:23], v230 offset:49152
    ds_read_b64_tr_b16 v[26:27], v234 offset:49152
    ds_read_b64_tr_b16 v[30:31], v238 offset:49152
    s_waitcnt lgkmcnt(4)
    s_add_u32 m0, s60, 32768
    s_add_u32 s53, s65, 98304
    buffer_load_dwordx4 v6, s[32:35], s53 offen lds
    s_add_u32 m0, s60, 36864
    s_add_u32 s53, s65, 114688
    buffer_load_dwordx4 v6, s[32:35], s53 offen lds
    s_mov_b32 s62, 0x20000
    s_mov_b64 exec, 0x3fff
    s_branch L_PCZ
L_POLLZ:
    buffer_load_dword v3, v9, s[36:39], 0 offen offset:128 sc1
    s_waitcnt vmcnt(0)
L_PCZ:
    v_cmp_ne_u32 vcc, s61, v3
    s_cbranch_vccz L_GOZ
    s_sub_u32 s62, s62, 1
    s_cbranch_scc1 L_GOZ
    s_sleep 4
    s_branch L_POLLZ
L_GOZ:
    s_mov_b64 exec, -1
    s_add_u32 s53, s60, 49152
    v_bfe_u32 v3, v2, 3, 2
    v_lshl_add_u32 v3, v3, 2, v7
    v_add_u32 v11, s53, v3
    v_xor_b32 v14, 256, v15
    s_and_b32 s53, s60, 2048
    s_add_u32 s53, s53, 49152
    v_add_u32 v0, s53, v7
    v_add_u32 v1, 57344, v0
    v_lshrrev_b32 v3, 5, v2
    v_lshlrev_b32 v3, 6, v3
    v_xor_b32 v3, v3, v7
    v_add_u32 v2, s60, v3
    s_barrier
    s_add_u32 m0, s60, 81920
    s_add_u32 s53, s66, 0
    buffer_load_dwordx4 v6, s[32:35], s53 offen lds
    s_add_u32 m0, s60, 86016
    s_add_u32 s53, s66, 16384
    buffer_load_dwordx4 v6, s[32:35], s53 offen lds
    s_add_u32 m0, s60, 90112
    s_add_u32 s53, s66, 32768
    buffer_load_dwordx4 v6, s[32:35], s53 offen lds
    s_add_u32 m0, s60, 94208
    s_add_u32 s53, s66, 49152
    buffer_load_dwordx4 v6, s[32:35], s53 offen lds
    s_add_u32 m0, s60, 98304
    s_add_u32 s53, s66, 65536
    buffer_load_dwordx4 v6, s[32:35], s53 offen lds
    s_add_u32 m0, s60, 102400
    s_add_u32 s53, s66, 81920
    buffer_load_dwordx4 v6, s[32:35], s53 offen lds
    s_add_u32 m0, s60, 106496
    s_add_u32 s53, s66, 98304
    buffer_load_dwordx4 v6, s[32:35], s53 offen lds
    s_add_u32 m0, s60, 110592
    s_add_u32 s53, s66, 114688
    buffer_load_dwordx4 v6, s[32:35], s53 offen lds
    s_add_u32 m0, s60, 114688
    s_add_u32 s53, s67, 0
    buffer_load_dwordx4 v6, s[32:35], s53 offen lds
    s_add_u32 m0, s60, 118784
    s_add_u32 s53, s67, 16384
    buffer_load_dwordx4 v6, s[32:35], s53 offen lds
    s_add_u32 m0, s60, 122880
    s_add_u32 s53, s67, 32768
    buffer_load_dwordx4 v6, s[32:35], s53 offen lds
    s_add_u32 m0, s60, 126976
    s_add_u32 s53, s67, 49152
    buffer_load_dwordx4 v6, s[32:35], s53 offen lds
    s_waitcnt vmcnt(22)
    ds_read_b64_tr_b16 v[32:33], v226 offset:57344
    ds_read_b64_tr_b16 v[36:37], v230 offset:57344
    ds_read_b64_tr_b16 v[40:41], v234 offset:57344
    ds_read_b64_tr_b16 v[44:45], v238 offset:57344
    s_waitcnt lgkmcnt(4)
    s_add_u32 m0, s60, 147456
    s_add_u32 s53, s67, 65536
    buffer_load_dwordx4 v6, s[32:35], s53 offen lds
    s_add_u32 m0, s60, 151552
    s_add_u32 s53, s67, 81920
    buffer_load_dwordx4 v6, s[32:35], s53 offen lds
    s_waitcnt vmcnt(22)
    ds_read_b64_tr_b16 v[34:35], v227 offset:16384
    ds_read_b64_tr_b16 v[38:39], v231 offset:16384
    ds_read_b64_tr_b16 v[42:43], v235 offset:16384
    ds_read_b64_tr_b16 v[46:47], v239 offset:16384
    s_waitcnt lgkmcnt(4)
    s_add_u32 m0, s60, 155648
    s_add_u32 s53, s67, 98304
    buffer_load_dwordx4 v6, s[32:35], s53 offen lds
    s_add_u32 m0, s60, 159744
    s_add_u32 s53, s67, 114688
    buffer_load_dwordx4 v6, s[32:35], s53 offen lds
    s_waitcnt vmcnt(22)
    ds_read_b64_tr_b16 v[48:49], v227 offset:24576
    ds_read_b64_tr_b16 v[52:53], v231 offset:24576
    ds_read_b64_tr_b16 v[56:57], v235 offset:24576
    ds_read_b64_tr_b16 v[60:61], v239 offset:24576
    s_waitcnt lgkmcnt(4)
    s_add_u32 m0, s60, 49152
    s_add_u32 s53, s68, 0
    buffer_load_dwordx4 v6, s[32:35], s53 offen lds
    s_add_u32 m0, s60, 53248
    s_add_u32 s53, s68, 16384
    buffer_load_dwordx4 v6, s[32:35], s53 offen lds
    s_waitcnt vmcnt(22)
    ds_read_b64_tr_b16 v[50:51], v227 offset:32768
    ds_read_b64_tr_b16 v[54:55], v231 offset:32768
    ds_read_b64_tr_b16 v[58:59], v235 offset:32768
    ds_read_b64_tr_b16 v[62:63], v239 offset:32768
    s_waitcnt lgkmcnt(4)
    s_add_u32 m0, s60, 57344
    s_add_u32 s53, s68, 32768
    buffer_load_dwordx4 v6, s[32:35], s53 offen lds
    s_add_u32 m0, s60, 61440
    s_add_u32 s53, s68, 49152
    buffer_load_dwordx4 v6, s[32:35], s53 offen lds
    s_waitcnt vmcnt(22)
    ds_read_b64_tr_b16 v[64:65], v227 offset:40960
    ds_read_b64_tr_b16 v[68:69], v231 offset:40960
    ds_read_b64_tr_b16 v[72:73], v235 offset:40960
    ds_read_b64_tr_b16 v[76:77], v239 offset:40960
    s_waitcnt lgkmcnt(4)
    s_add_u32 m0, s60, 65536
    s_add_u32 s53, s68, 65536
    buffer_load_dwordx4 v6, s[32:35], s53 offen lds
    s_add_u32 m0, s60, 69632
    s_add_u32 s53, s68, 81920
    buffer_load_dwordx4 v6, s[32:35], s53 offen lds
    s_mov_b32 s62, 0x100000
L_DRW:
    ds_read_b32 v245, v244 offset:2048
    s_sub_u32 s62, s62, 1
    s_cbranch_scc1 L_DRX
    s_waitcnt lgkmcnt(0)
    v_cmp_eq_u32 vcc, 0, v245
    s_cbranch_vccnz L_DRW
L_DRX:
    s_add_u32 m0, s60, 131072
    s_add_u32 s53, s68, 98304
    buffer_load_dwordx4 v6, s[32:35], s53 offen lds
    s_add_u32 m0, s60, 135168
    s_add_u32 s53, s68, 114688
    buffer_load_dwordx4 v6, s[32:35], s53 offen lds
    s_add_u32 m0, s60, 139264
    s_add_u32 s53, s69, 0
    buffer_load_dwordx4 v6, s[32:35], s53 offen lds
    s_add_u32 m0, s60, 143360
    s_add_u32 s53, s69, 16384
    buffer_load_dwordx4 v6, s[32:35], s53 offen lds
    s_waitcnt vmcnt(26)
    ds_read_b64_tr_b16 v[66:67], v227 offset:0
    ds_read_b64_tr_b16 v[70:71], v231 offset:0
    ds_read_b64_tr_b16 v[74:75], v235 offset:0
    ds_read_b64_tr_b16 v[78:79], v239 offset:0
    s_waitcnt vmcnt(24)
    ds_read_b64_tr_b16 v[80:81], v227 offset:49152
    ds_read_b64_tr_b16 v[84:85], v231 offset:49152
    ds_read_b64_tr_b16 v[88:89], v235 offset:49152
    ds_read_b64_tr_b16 v[92:93], v239 offset:49152
    s_waitcnt lgkmcnt(4)
    s_add_u32 m0, s60, 32768
    s_add_u32 s53, s69, 32768
    buffer_load_dwordx4 v6, s[32:35], s53 offen lds
    s_add_u32 m0, s60, 36864
    s_add_u32 s53, s69, 49152
    buffer_load_dwordx4 v6, s[32:35], s53 offen lds
    s_waitcnt vmcnt(24)
    ds_read_b64_tr_b16 v[82:83], v227 offset:57344
    ds_read_b64_tr_b16 v[86:87], v231 offset:57344
    ds_read_b64_tr_b16 v[90:91], v235 offset:57344
    ds_read_b64_tr_b16 v[94:95], v239 offset:57344
    s_waitcnt vmcnt(22)
    ds_read_b64_tr_b16 v[96:97], v226 offset:0
    ds_read_b64_tr_b16 v[100:101], v230 offset:0
    ds_read_b64_tr_b16 v[104:105], v234 offset:0
    ds_read_b64_tr_b16 v[108:109], v238 offset:0
    s_waitcnt vmcnt(20)
    ds_read_b64_tr_b16 v[98:99], v226 offset:8192
    ds_read_b64_tr_b16 v[102:103], v230 offset:8192
    ds_read_b64_tr_b16 v[106:107], v234 offset:8192
    ds_read_b64_tr_b16 v[110:111], v238 offset:8192
    s_waitcnt vmcnt(18)
    ds_read_b64_tr_b16 v[112:113], v226 offset:16384
    ds_read_b64_tr_b16 v[116:117], v230 offset:16384
    ds_read_b64_tr_b16 v[120:121], v234 offset:16384
    ds_read_b64_tr_b16 v[124:125], v238 offset:16384
    s_waitcnt lgkmcnt(4)
    s_add_u32 m0, s60, 106496
    s_add_u32 s53, s69, 65536
    buffer_load_dwordx4 v6, s[32:35], s53 offen lds
    s_add_u32 m0, s60, 110592
    s_add_u32 s53, s69, 81920
    buffer_load_dwordx4 v6, s[32:35], s53 offen lds
    s_waitcnt vmcnt(18)
    ds_read_b64_tr_b16 v[114:115], v226 offset:24576
    ds_read_b64_tr_b16 v[118:119], v230 offset:24576
    ds_read_b64_tr_b16 v[122:123], v234 offset:24576
    ds_read_b64_tr_b16 v[126:127], v238 offset:24576
    s_waitcnt lgkmcnt(4)
    s_add_u32 m0, s60, 114688
    s_add_u32 s53, s69, 98304
    buffer_load_dwordx4 v6, s[32:35], s53 offen lds
    s_add_u32 m0, s60, 118784
    s_add_u32 s53, s69, 114688
    buffer_load_dwordx4 v6, s[32:35], s53 offen lds
    s_waitcnt vmcnt(18)
    ds_read_b64_tr_b16 v[128:129], v226 offset:49152
    ds_read_b64_tr_b16 v[132:133], v230 offset:49152
    ds_read_b64_tr_b16 v[136:137], v234 offset:49152
    ds_read_b64_tr_b16 v[140:141], v238 offset:49152
    s_waitcnt lgkmcnt(4)
    s_add_u32 m0, s60, 122880
    s_add_u32 s53, s70, 0
    buffer_load_dwordx4 v6, s[32:35], s53 offen lds
    s_add_u32 m0, s60, 126976
    s_add_u32 s53, s70, 16384
    buffer_load_dwordx4 v6, s[32:35], s53 offen lds
    s_waitcnt vmcnt(18)
    ds_read_b64_tr_b16 v[130:131], v226 offset:57344
    ds_read_b64_tr_b16 v[134:135], v230 offset:57344
    ds_read_b64_tr_b16 v[138:139], v234 offset:57344
    ds_read_b64_tr_b16 v[142:143], v238 offset:57344
    s_waitcnt lgkmcnt(4)
    s_add_u32 m0, s60, 147456
    s_add_u32 s53, s70, 32768
    buffer_load_dwordx4 v6, s[32:35], s53 offen lds
    s_add_u32 m0, s60, 151552
    s_add_u32 s53, s70, 49152
    buffer_load_dwordx4 v6, s[32:35], s53 offen lds
    s_waitcnt vmcnt(18)
    ds_read_b64_tr_b16 v[144:145], v227 offset:16384
    ds_read_b64_tr_b16 v[148:149], v231 offset:16384
    ds_read_b64_tr_b16 v[152:153], v235 offset:16384
    ds_read_b64_tr_b16 v[156:157], v239 offset:16384
    s_waitcnt lgkmcnt(4)
    s_add_u32 m0, s60, 155648
    s_add_u32 s53, s70, 65536
    buffer_load_dwordx4 v6, s[32:35], s53 offen lds
    s_add_u32 m0, s60, 159744
    s_add_u32 s53, s70, 81920
    buffer_load_dwordx4 v6, s[32:35], s53 offen lds
    s_waitcnt vmcnt(18)
    ds_read_b64_tr_b16 v[146:147], v227 offset:24576
    ds_read_b64_tr_b16 v[150:151], v231 offset:24576
    ds_read_b64_tr_b16 v[154:155], v235 offset:24576
    ds_read_b64_tr_b16 v[158:159], v239 offset:24576
    s_waitcnt vmcnt(16)
    ds_read_b64_tr_b16 v[160:161], v227 offset:32768
    ds_read_b64_tr_b16 v[164:165], v231 offset:32768
    ds_read_b64_tr_b16 v[168:169], v235 offset:32768
    ds_read_b64_tr_b16 v[172:173], v239 offset:32768
    s_mov_b32 s62, 0x8000
L_FW:
    ds_read_b32 v3, v15
    s_waitcnt lgkmcnt(0)
    v_cmp_ne_u32 vcc, 0, v3
    s_cbranch_vccnz L_P2M
    s_sub_u32 s62, s62, 1
    s_cbranch_scc1 L_P2M
    s_sleep 1
    s_branch L_FW
    .fill 505, 4, 0xbf810000
L_PAD_comp:
    s_branch L_DISP
L_COMPUTE:
    v_and_b32 v3, 15, v2
    v_lshrrev_b32 v4, 4, v2
    v_bfe_u32 v5, v2, 1, 3
    v_lshlrev_b32 v3, 7, v3
    v_add_u32 v3, 32768, v3
    v_xor_b32 v5, v5, v4
    v_lshl_add_u32 v16, v5, 4, v3
    v_xor_b32 v5, 4, v5
    v_lshl_add_u32 v17, v5, 4, v3
    v_bfe_u32 v5, v2, 2, 2
    v_lshl_add_u32 v3, v4, 3, v5
    v_lshlrev_b32 v3, 8, v3
    v_and_b32 v4, 3, v2
    v_lshl_add_u32 v3, v4, 3, v3
    v_add_u32 v3, 114688, v3
    v_bfe_u32 v5, v2, 2, 3
    s_lshl_b32 s53, s48, 1
    s_add_u32 s54, s53, 0
    v_xor_b32 v4, s54, v5
    v_lshl_add_u32 v18, v4, 5, v3
    s_add_u32 s54, s53, 1
    v_xor_b32 v4, s54, v5
    v_lshl_add_u32 v19, v4, 5, v3
    v_mov_b32 v128, 0
    v_mov_b32 v129, 0
    v_mov_b32 v130, 0
    v_mov_b32 v131, 0
    v_mov_b32 v132, 0
    v_mov_b32 v133, 0
    v_mov_b32 v134, 0
    v_mov_b32 v135, 0
    v_mov_b32 v136, 0
    v_mov_b32 v137, 0
    v_mov_b32 v138, 0
    v_mov_b32 v139, 0
    v_mov_b32 v140, 0
    v_mov_b32 v141, 0
    v_mov_b32 v142, 0
    v_mov_b32 v143, 0
    v_mov_b32 v144, 0
    v_mov_b32 v145, 0
    v_mov_b32 v146, 0
    v_mov_b32 v147, 0
    v_mov_b32 v148, 0
    v_mov_b32 v149, 0
    v_mov_b32 v150, 0
    v_mov_b32 v151, 0
    v_mov_b32 v152, 0
    v_mov_b32 v153, 0
    v_mov_b32 v154, 0
    v_mov_b32 v155, 0
    v_mov_b32 v156, 0
    v_mov_b32 v157, 0
    v_mov_b32 v158, 0
    v_mov_b32 v159, 0
    v_mov_b32 v160, 0
    v_mov_b32 v161, 0
    v_mov_b32 v162, 0
    v_mov_b32 v163, 0
    v_mov_b32 v164, 0
    v_mov_b32 v165, 0
    v_mov_b32 v166, 0
    v_mov_b32 v167, 0
    v_mov_b32 v168, 0
    v_mov_b32 v169, 0
    v_mov_b32 v170, 0
    v_mov_b32 v171, 0
    v_mov_b32 v172, 0
    v_mov_b32 v173, 0
    v_mov_b32 v174, 0
    v_mov_b32 v175, 0
    v_mov_b32 v176, 0
    v_mov_b32 v177, 0
    v_mov_b32 v178, 0
    v_mov_b32 v179, 0
    v_mov_b32 v180, 0
    v_mov_b32 v181, 0
    v_mov_b32 v182, 0
    v_mov_b32 v183, 0
    v_mov_b32 v184, 0
    v_mov_b32 v185, 0
    v_mov_b32 v186, 0
    v_mov_b32 v187, 0
    v_mov_b32 v188, 0
    v_mov_b32 v189, 0
    v_mov_b32 v190, 0
    v_mov_b32 v191, 0
    v_mov_b32 v192, 0
    v_mov_b32 v193, 0
    v_mov_b32 v194, 0
    v_mov_b32 v195, 0
    v_mov_b32 v196, 0
    v_mov_b32 v197, 0
    v_mov_b32 v198, 0
    v_mov_b32 v199, 0
    v_mov_b32 v200, 0
    v_mov_b32 v201, 0
    v_mov_b32 v202, 0
    v_mov_b32 v203, 0
    v_mov_b32 v204, 0
    v_mov_b32 v205, 0
    v_mov_b32 v206, 0
    v_mov_b32 v207, 0
    v_mov_b32 v208, 0
    v_mov_b32 v209, 0
    v_mov_b32 v210, 0
    v_mov_b32 v211, 0
    v_mov_b32 v212, 0
    v_mov_b32 v213, 0
    v_mov_b32 v214, 0
    v_mov_b32 v215, 0
    v_mov_b32 v216, 0
    v_mov_b32 v217, 0
    v_mov_b32 v218, 0
    v_mov_b32 v219, 0
    v_mov_b32 v220, 0
    v_mov_b32 v221, 0
    v_mov_b32 v222, 0
    v_mov_b32 v223, 0
    v_mov_b32 v224, 0
    v_mov_b32 v225, 0
    v_mov_b32 v226, 0
    v_mov_b32 v227, 0
    v_mov_b32 v228, 0
    v_mov_b32 v229, 0
    v_mov_b32 v230, 0
    v_mov_b32 v231, 0
    v_mov_b32 v232, 0
    v_mov_b32 v233, 0
    v_mov_b32 v234, 0
    v_mov_b32 v235, 0
    v_mov_b32 v236, 0
    v_mov_b32 v237, 0
    v_mov_b32 v238, 0
L_PAD_comp.3:
    s_cbranch_execz L_DISP
    v_mov_b32 v239, 0
    v_mov_b32 v240, 0
    v_mov_b32 v241, 0
    v_mov_b32 v242, 0
    v_mov_b32 v243, 0
    v_mov_b32 v244, 0
    v_mov_b32 v245, 0
    v_mov_b32 v246, 0
    v_mov_b32 v247, 0
    v_mov_b32 v248, 0
    v_mov_b32 v249, 0
    v_mov_b32 v250, 0
    v_mov_b32 v251, 0
    v_mov_b32 v252, 0
    v_mov_b32 v253, 0
    v_mov_b32 v254, 0
    v_mov_b32 v255, 0
    s_and_b32 s53, s48, 1
    s_mul_i32 s54, s52, 932
    s_mul_i32 s18, s53, 464
    s_add_u32 s18, s18, s54
    s_mul_i32 s54, s51, 4
    s_add_u32 s18, s18, s54
    s_and_b32 s54, s48, 2
    s_add_u32 s18, s18, s54
    s_lshl_b32 s18, s18, 10
    s_add_u32 s18, s18, 65536
    s_lshl_b32 s54, s54, 7
    s_lshl_b32 s53, s53, 2
    s_add_u32 s19, s53, s54
    s_lshl_b32 s53, s52, 2
    s_add_u32 s53, s53, s59
    s_lshl_b32 s53, s53, 9
    s_add_u32 s19, s19, s53
    s_mul_i32 s53, s59, 7
    s_sub_u32 s53, s51, s53
    s_lshl_b32 s53, s53, 3
    s_add_u32 s19, s19, s53
    s_add_u32 s19, s19, 14680064
    s_mul_i32 s18, s52, 932
    s_mul_i32 s54, s51, 4
    s_add_u32 s18, s18, s54
    s_add_u32 s18, s18, s48
    s_lshl_b32 s18, s18, 10
    s_add_u32 s18, s18, 65536
    s_mov_b32 s30, 0xbfb8aa3b
    s_waitcnt lgkmcnt(0)
    s_mov_b32 s32, s16
    s_and_b32 s33, s17, 0xffff
    s_mov_b32 s34, 268435456
    s_mov_b32 s35, 0x00020000
    s_mov_b32 s36, s16
    s_and_b32 s37, s17, 0xffff
    s_mov_b32 s38, 268435456
    s_mov_b32 s39, 0x00020000
    s_mov_b32 s40, s12
    s_and_b32 s41, s13, 0xffff
    s_mov_b32 s42, 2097152
    s_mov_b32 s43, 0x00020000
    s_mov_b32 s44, s14
    s_and_b32 s45, s15, 0xffff
    s_mov_b32 s46, 256
    s_mov_b32 s47, 0x00020000
    s_lshl_b32 s60, s48, 10
    s_and_b32 s60, s60, 3072
    v_lshlrev_b32 v7, 4, v2
    v_mov_b32 v10, 0
    v_lshrrev_b32 v3, 3, v2
    v_and_b32 v4, 6, v3
    v_lshlrev_b32 v3, 11, v3
    v_and_b32 v5, 7, v2
    v_xor_b32 v4, v4, v5
    v_lshl_add_u32 v3, v4, 4, v3
    s_and_b32 s53, s48, 2
    s_lshl_b32 s53, s53, 16
    s_and_b32 s54, s48, 1
    s_lshl_b32 s54, s54, 7
    s_add_u32 s53, s53, s54
    v_add_u32 v6, s53, v3
    s_mul_i32 s54, s59, 1835008
    s_lshl_b32 s53, s50, 8
    s_add_u32 s54, s54, s53
    s_mul_i32 s7, s49, 954368
    s_mul_i32 s53, s59, 28672
    s_add_u32 s7, s7, s53
    s_add_u32 s7, s7, s60
    s_add_u32 s7, s7, 65536
    s_mov_b32 s3, s7
    s_and_b32 s53, s50, 3
    s_mul_i32 s53, s53, 0
    s_add_u32 s53, s53, s49
    s_sub_u32 s8, s53, 7
    s_cselect_b32 s53, s53, s8
    s_lshl_b32 s8, s53, 18
    s_add_u32 s64, s54, s8
    s_mul_i32 s8, s53, 4096
    s_add_u32 s71, s8, s7
    s_add_u32 s53, s53, 1
    s_cmp_eq_u32 s53, 7
    s_cselect_b32 s53, 0, s53
    s_lshl_b32 s8, s53, 18
    s_add_u32 s65, s54, s8
    s_mul_i32 s8, s53, 4096
    s_add_u32 s72, s8, s7
    s_add_u32 s53, s53, 1
    s_cmp_eq_u32 s53, 7
    s_cselect_b32 s53, 0, s53
    s_lshl_b32 s8, s53, 18
    s_add_u32 s66, s54, s8
    s_mul_i32 s8, s53, 4096
    s_add_u32 s73, s8, s7
    s_add_u32 s53, s53, 1
    s_cmp_eq_u32 s53, 7
    s_cselect_b32 s53, 0, s53
    s_lshl_b32 s8, s53, 18
    s_add_u32 s67, s54, s8
    s_mul_i32 s8, s53, 4096
    s_add_u32 s74, s8, s7
    s_add_u32 s53, s53, 1
    s_cmp_eq_u32 s53, 7
    s_cselect_b32 s53, 0, s53
    s_lshl_b32 s8, s53, 18
    s_add_u32 s68, s54, s8
    s_mul_i32 s8, s53, 4096
    s_add_u32 s75, s8, s7
    s_add_u32 s53, s53, 1
    s_cmp_eq_u32 s53, 7
    s_cselect_b32 s53, 0, s53
    s_lshl_b32 s8, s53, 18
    s_add_u32 s69, s54, s8
    s_mul_i32 s8, s53, 4096
    s_add_u32 s76, s8, s7
    s_add_u32 s53, s53, 1
    s_cmp_eq_u32 s53, 7
    s_cselect_b32 s53, 0, s53
    s_lshl_b32 s8, s53, 18
    s_add_u32 s70, s54, s8
    s_mul_i32 s8, s53, 4096
    s_add_u32 s77, s8, s7
    s_movk_i32 s11, 0xff
    s_lshl_b32 s53, s49, 2
    s_add_u32 s53, s53, s59
    s_lshl_b32 s53, s53, 9
    s_and_b32 s54, s48, 2
    s_lshl_b32 s54, s54, 7
    s_add_u32 s53, s53, s54
    s_add_u32 s14, s53, 14680064
    v_lshlrev_b32 v3, 2, v2
    v_add_u32 v9, s14, v3
    s_lshl_b32 s7, s49, 3
    s_add_u32 s7, s7, s50
    s_mul_i32 s7, s7, 196608
    s_lshl_b32 s54, s60, 1
    s_add_u32 s7, s7, s54
    s_add_u32 s7, s7, 16777216
    s_add_u32 s53, s59, 1
    s_and_b32 s53, s53, 3
    s_mul_i32 s53, s53, 49152
    s_add_u32 s53, s53, 0
    s_add_u32 s4, s53, s7
    s_add_u32 s53, s59, 2
    s_and_b32 s53, s53, 3
    s_mul_i32 s53, s53, 49152
    s_add_u32 s53, s53, 16384
    s_add_u32 s5, s53, s7
    s_add_u32 s53, s59, 3
    s_and_b32 s53, s53, 3
    s_mul_i32 s53, s53, 49152
    s_add_u32 s53, s53, 32768
    s_add_u32 s6, s53, s7
    s_mul_i32 s54, s59, 49152
    s_add_u32 s7, s7, s54
    s_lshl_b32 s53, s49, 3
    s_add_u32 s53, s53, s59
    s_lshl_b32 s8, s53, 15
    s_lshl_b32 s53, s50, 8
    s_add_u32 s8, s8, s53
    s_and_b32 s53, s48, 1
    s_lshl_b32 s53, s53, 7
    s_add_u32 s8, s8, s53
    s_and_b32 s53, s48, 2
    s_lshl_b32 s53, s53, 5
    s_add_u32 s8, s8, s53
    v_lshrrev_b32 v3, 2, v2
    v_lshlrev_b32 v3, 11, v3
    v_and_b32 v4, 3, v2
    v_lshl_add_u32 v0, v4, 4, v3
    s_and_b32 s53, s48, 1
    s_lshl_b32 s53, s53, 10
    s_and_b32 s54, s48, 2
    s_lshl_b32 s54, s54, 12
    s_add_u32 s53, s53, s54
    v_lshrrev_b32 v3, 2, v2
    v_lshlrev_b32 v5, 2, v4
    v_xor_b32 v3, v3, v5
    v_lshlrev_b32 v3, 4, v3
    v_and_b32 v5, 1, v2
    v_lshl_add_u32 v3, v5, 9, v3
    v_lshrrev_b32 v5, 1, v4
    v_lshl_add_u32 v3, v5, 12, v3
    v_add_u32 v1, s53, v3
    s_add_u32 s53, s60, 49152
    v_add_u32 v28, s53, v7
    v_add_u32 v29, 57344, v28
    v_bfe_u32 v3, v2, 3, 2
    v_lshl_add_u32 v11, v3, 2, v28
    v_add_u32 v12, 57344, v11
L_PAD_comp.4:
    s_cbranch_execz L_DISP
    s_lshr_b32 s53, s60, 2
    s_add_u32 s53, s53, 45056
    v_lshlrev_b32 v15, 2, v2
    v_add_u32 v15, s53, v15
    v_and_b32 v21, 3, v2
    v_lshlrev_b32 v21, 6, v21
    v_add_u32 v21, v21, v2
    v_lshlrev_b32 v21, 2, v21
    v_add_u32 v21, 45056, v21
    s_mov_b32 s22, 0
    s_mov_b32 s23, 3
    s_mov_b32 s25, 2
    s_movk_i32 s27, 16384
    s_setprio 3
L_B0:
    s_barrier
    ds_read_b64_tr_b16 v[64:65], v18 offset:0
    ds_read_b128 v[32:35], v16 offset:0
    ds_read_b64_tr_b16 v[66:67], v18 offset:1024
    ds_read_b128 v[36:39], v16 offset:8192
    ds_read_b64_tr_b16 v[68:69], v19 offset:0
    ds_read_b128 v[40:43], v16 offset:2048
    ds_read_b64_tr_b16 v[70:71], v19 offset:1024
    ds_read_b128 v[44:47], v16 offset:10240
    ds_read_b64_tr_b16 v[72:73], v18 offset:8192
    ds_read_b128 v[48:51], v16 offset:4096
    ds_read_b64_tr_b16 v[74:75], v18 offset:9216
    ds_read_b128 v[52:55], v16 offset:12288
    ds_read_b64_tr_b16 v[76:77], v19 offset:8192
    ds_read_b128 v[56:59], v16 offset:6144
    ds_read_b64_tr_b16 v[78:79], v19 offset:9216
    ds_read_b128 v[60:63], v16 offset:14336
    s_add_u32 s23, s23, 1
    s_cmp_eq_u32 s23, 6
    s_cselect_b32 s24, -81920, s27
    s_cselect_b32 s23, 0, s23
    v_add_u32 v18, s24, v18
    v_add_u32 v19, s24, v19
L_LOOP:
    s_waitcnt lgkmcnt(0)
    v_mfma_f32_16x16x32_bf16 v[128:131], v[64:67], v[32:35], v[128:131]
    s_barrier
    v_mfma_f32_16x16x32_bf16 v[132:135], v[68:71], v[32:35], v[132:135]
    ds_read_b64_tr_b16 v[112:113], v18 offset:0
    v_mfma_f32_16x16x32_bf16 v[140:143], v[76:79], v[32:35], v[140:143]
    ds_read_b128 v[80:83], v17 offset:0
    v_mfma_f32_16x16x32_bf16 v[136:139], v[72:75], v[32:35], v[136:139]
    ds_read_b64_tr_b16 v[114:115], v18 offset:1024
    v_mfma_f32_16x16x32_bf16 v[152:155], v[72:75], v[36:39], v[152:155]
    ds_read_b128 v[84:87], v17 offset:8192
    v_mfma_f32_16x16x32_bf16 v[156:159], v[76:79], v[36:39], v[156:159]
    ds_read_b64_tr_b16 v[116:117], v19 offset:0
    v_mfma_f32_16x16x32_bf16 v[148:151], v[68:71], v[36:39], v[148:151]
    ds_read_b128 v[88:91], v17 offset:2048
    v_mfma_f32_16x16x32_bf16 v[144:147], v[64:67], v[36:39], v[144:147]
    ds_read_b64_tr_b16 v[118:119], v19 offset:1024
    v_mfma_f32_16x16x32_bf16 v[160:163], v[64:67], v[40:43], v[160:163]
    ds_read_b128 v[92:95], v17 offset:10240
    v_mfma_f32_16x16x32_bf16 v[164:167], v[68:71], v[40:43], v[164:167]
    ds_read_b64_tr_b16 v[120:121], v18 offset:8192
    v_mfma_f32_16x16x32_bf16 v[172:175], v[76:79], v[40:43], v[172:175]
    ds_read_b128 v[96:99], v17 offset:4096
    v_mfma_f32_16x16x32_bf16 v[168:171], v[72:75], v[40:43], v[168:171]
    ds_read_b64_tr_b16 v[122:123], v18 offset:9216
    v_mfma_f32_16x16x32_bf16 v[184:187], v[72:75], v[44:47], v[184:187]
    ds_read_b128 v[100:103], v17 offset:12288
    v_mfma_f32_16x16x32_bf16 v[188:191], v[76:79], v[44:47], v[188:191]
    ds_read_b64_tr_b16 v[124:125], v19 offset:8192
    s_add_u32 s23, s23, 1
    s_cmp_eq_u32 s23, 6
    v_mfma_f32_16x16x32_bf16 v[180:183], v[68:71], v[44:47], v[180:183]
    ds_read_b128 v[104:107], v17 offset:6144
    s_cselect_b32 s24, -81920, s27
    s_cselect_b32 s23, 0, s23
    v_mfma_f32_16x16x32_bf16 v[176:179], v[64:67], v[44:47], v[176:179]
    ds_read_b64_tr_b16 v[126:127], v19 offset:9216
    s_add_u32 s25, s25, 1
    s_cmp_eq_u32 s25, 4
    v_mfma_f32_16x16x32_bf16 v[192:195], v[64:67], v[48:51], v[192:195]
    ds_read_b128 v[108:111], v17 offset:14336
    s_cselect_b32 s26, -49152, s27
    s_cselect_b32 s25, 0, s25
    v_mfma_f32_16x16x32_bf16 v[196:199], v[68:71], v[48:51], v[196:199]
    v_add_u32 v18, s24, v18
    v_mfma_f32_16x16x32_bf16 v[204:207], v[76:79], v[48:51], v[204:207]
    v_add_u32 v19, s24, v19
    v_mfma_f32_16x16x32_bf16 v[200:203], v[72:75], v[48:51], v[200:203]
    v_add_u32 v16, s26, v16
    v_mfma_f32_16x16x32_bf16 v[216:219], v[72:75], v[52:55], v[216:219]
    v_add_u32 v17, s26, v17
    v_mfma_f32_16x16x32_bf16 v[220:223], v[76:79], v[52:55], v[220:223]
    v_mfma_f32_16x16x32_bf16 v[212:215], v[68:71], v[52:55], v[212:215]
    v_mfma_f32_16x16x32_bf16 v[208:211], v[64:67], v[52:55], v[208:211]
    v_mfma_f32_16x16x32_bf16 v[224:227], v[64:67], v[56:59], v[224:227]
    v_mfma_f32_16x16x32_bf16 v[228:231], v[68:71], v[56:59], v[228:231]
    v_mfma_f32_16x16x32_bf16 v[236:239], v[76:79], v[56:59], v[236:239]
    v_mfma_f32_16x16x32_bf16 v[232:235], v[72:75], v[56:59], v[232:235]
    v_mfma_f32_16x16x32_bf16 v[248:251], v[72:75], v[60:63], v[248:251]
    v_mfma_f32_16x16x32_bf16 v[252:255], v[76:79], v[60:63], v[252:255]
    v_mfma_f32_16x16x32_bf16 v[244:247], v[68:71], v[60:63], v[244:247]
    v_mfma_f32_16x16x32_bf16 v[240:243], v[64:67], v[60:63], v[240:243]
    s_add_u32 s22, s22, 1
    s_cmp_eq_u32 s22, 14
    s_waitcnt lgkmcnt(0)
    s_cbranch_scc1 L_LAST
    v_mfma_f32_16x16x32_bf16 v[128:131], v[112:115], v[80:83], v[128:131]
    s_barrier
    v_mfma_f32_16x16x32_bf16 v[132:135], v[116:119], v[80:83], v[132:135]
    ds_read_b64_tr_b16 v[64:65], v18 offset:0
    v_mfma_f32_16x16x32_bf16 v[140:143], v[124:127], v[80:83], v[140:143]
    ds_read_b128 v[32:35], v16 offset:0
    v_mfma_f32_16x16x32_bf16 v[136:139], v[120:123], v[80:83], v[136:139]
    ds_read_b64_tr_b16 v[66:67], v18 offset:1024
    v_mfma_f32_16x16x32_bf16 v[152:155], v[120:123], v[84:87], v[152:155]
    ds_read_b128 v[36:39], v16 offset:8192
    v_mfma_f32_16x16x32_bf16 v[156:159], v[124:127], v[84:87], v[156:159]
    ds_read_b64_tr_b16 v[68:69], v19 offset:0
    v_mfma_f32_16x16x32_bf16 v[148:151], v[116:119], v[84:87], v[148:151]
    ds_read_b128 v[40:43], v16 offset:2048
    v_mfma_f32_16x16x32_bf16 v[144:147], v[112:115], v[84:87], v[144:147]
    ds_read_b64_tr_b16 v[70:71], v19 offset:1024
    v_mfma_f32_16x16x32_bf16 v[160:163], v[112:115], v[88:91], v[160:163]
    ds_read_b128 v[44:47], v16 offset:10240
    v_mfma_f32_16x16x32_bf16 v[164:167], v[116:119], v[88:91], v[164:167]
    ds_read_b64_tr_b16 v[72:73], v18 offset:8192
    v_mfma_f32_16x16x32_bf16 v[172:175], v[124:127], v[88:91], v[172:175]
    ds_read_b128 v[48:51], v16 offset:4096
    v_mfma_f32_16x16x32_bf16 v[168:171], v[120:123], v[88:91], v[168:171]
    ds_read_b64_tr_b16 v[74:75], v18 offset:9216
    v_mfma_f32_16x16x32_bf16 v[184:187], v[120:123], v[92:95], v[184:187]
    ds_read_b128 v[52:55], v16 offset:12288
    v_mfma_f32_16x16x32_bf16 v[188:191], v[124:127], v[92:95], v[188:191]
    ds_read_b64_tr_b16 v[76:77], v19 offset:8192
    s_add_u32 s23, s23, 1
    s_cmp_eq_u32 s23, 6
    v_mfma_f32_16x16x32_bf16 v[180:183], v[116:119], v[92:95], v[180:183]
    ds_read_b128 v[56:59], v16 offset:6144
    s_cselect_b32 s24, -81920, s27
    s_cselect_b32 s23, 0, s23
    v_mfma_f32_16x16x32_bf16 v[176:179], v[112:115], v[92:95], v[176:179]
    ds_read_b64_tr_b16 v[78:79], v19 offset:9216
    v_mfma_f32_16x16x32_bf16 v[192:195], v[112:115], v[96:99], v[192:195]
    ds_read_b128 v[60:63], v16 offset:14336
    v_mfma_f32_16x16x32_bf16 v[196:199], v[116:119], v[96:99], v[196:199]
    v_add_u32 v18, s24, v18
    v_mfma_f32_16x16x32_bf16 v[204:207], v[124:127], v[96:99], v[204:207]
    v_add_u32 v19, s24, v19
    v_mfma_f32_16x16x32_bf16 v[200:203], v[120:123], v[96:99], v[200:203]
    v_mfma_f32_16x16x32_bf16 v[216:219], v[120:123], v[100:103], v[216:219]
    v_mfma_f32_16x16x32_bf16 v[220:223], v[124:127], v[100:103], v[220:223]
    v_mfma_f32_16x16x32_bf16 v[212:215], v[116:119], v[100:103], v[212:215]
    v_mfma_f32_16x16x32_bf16 v[208:211], v[112:115], v[100:103], v[208:211]
    v_mfma_f32_16x16x32_bf16 v[224:227], v[112:115], v[104:107], v[224:227]
    v_mfma_f32_16x16x32_bf16 v[228:231], v[116:119], v[104:107], v[228:231]
    v_mfma_f32_16x16x32_bf16 v[236:239], v[124:127], v[104:107], v[236:239]
    v_mfma_f32_16x16x32_bf16 v[232:235], v[120:123], v[104:107], v[232:235]
    v_mfma_f32_16x16x32_bf16 v[248:251], v[120:123], v[108:111], v[248:251]
    v_mfma_f32_16x16x32_bf16 v[252:255], v[124:127], v[108:111], v[252:255]
    v_mfma_f32_16x16x32_bf16 v[244:247], v[116:119], v[108:111], v[244:247]
    v_mfma_f32_16x16x32_bf16 v[240:243], v[112:115], v[108:111], v[240:243]
    s_branch L_LOOP
L_LAST:
    v_mfma_f32_16x16x32_bf16 v[128:131], v[112:115], v[80:83], v[128:131]
    s_barrier
    v_mfma_f32_16x16x32_bf16 v[132:135], v[116:119], v[80:83], v[132:135]
    ds_read_b64_tr_b16 v[32:33], v18 offset:0
    v_mfma_f32_16x16x32_bf16 v[140:143], v[124:127], v[80:83], v[140:143]
    ds_read_b64_tr_b16 v[34:35], v18 offset:1024
    v_mfma_f32_16x16x32_bf16 v[136:139], v[120:123], v[80:83], v[136:139]
    ds_read_b64_tr_b16 v[36:37], v19 offset:0
    v_mfma_f32_16x16x32_bf16 v[152:155], v[120:123], v[84:87], v[152:155]
    ds_read_b64_tr_b16 v[38:39], v19 offset:1024
    v_mfma_f32_16x16x32_bf16 v[156:159], v[124:127], v[84:87], v[156:159]
    ds_read_b64_tr_b16 v[40:41], v18 offset:8192
    v_mfma_f32_16x16x32_bf16 v[148:151], v[116:119], v[84:87], v[148:151]
    ds_read_b64_tr_b16 v[42:43], v18 offset:9216
    v_mfma_f32_16x16x32_bf16 v[144:147], v[112:115], v[84:87], v[144:147]
    ds_read_b64_tr_b16 v[44:45], v19 offset:8192
    v_mfma_f32_16x16x32_bf16 v[160:163], v[112:115], v[88:91], v[160:163]
    ds_read_b64_tr_b16 v[46:47], v19 offset:9216
    v_mfma_f32_16x16x32_bf16 v[164:167], v[116:119], v[88:91], v[164:167]
    ds_read_b128 v[64:67], v16 offset:0
    v_mfma_f32_16x16x32_bf16 v[172:175], v[124:127], v[88:91], v[172:175]
    ds_read_b64_tr_b16 v[48:49], v18 offset:16384
    v_mfma_f32_16x16x32_bf16 v[168:171], v[120:123], v[88:91], v[168:171]
    ds_read_b64_tr_b16 v[50:51], v18 offset:17408
    v_mfma_f32_16x16x32_bf16 v[184:187], v[120:123], v[92:95], v[184:187]
    ds_read_b64_tr_b16 v[52:53], v19 offset:16384
    v_mfma_f32_16x16x32_bf16 v[188:191], v[124:127], v[92:95], v[188:191]
    ds_read_b64_tr_b16 v[54:55], v19 offset:17408
    v_mfma_f32_16x16x32_bf16 v[180:183], v[116:119], v[92:95], v[180:183]
    ds_read_b64_tr_b16 v[56:57], v18 offset:24576
    v_mfma_f32_16x16x32_bf16 v[176:179], v[112:115], v[92:95], v[176:179]
    ds_read_b64_tr_b16 v[58:59], v18 offset:25600
    v_mfma_f32_16x16x32_bf16 v[192:195], v[112:115], v[96:99], v[192:195]
    ds_read_b64_tr_b16 v[60:61], v19 offset:24576
    v_mfma_f32_16x16x32_bf16 v[196:199], v[116:119], v[96:99], v[196:199]
    ds_read_b64_tr_b16 v[62:63], v19 offset:25600
    v_mfma_f32_16x16x32_bf16 v[204:207], v[124:127], v[96:99], v[204:207]
    ds_read_b128 v[68:71], v17 offset:0
    v_mfma_f32_16x16x32_bf16 v[200:203], v[120:123], v[96:99], v[200:203]
    ds_read_b128 v[72:75], v16 offset:8192
    v_mfma_f32_16x16x32_bf16 v[216:219], v[120:123], v[100:103], v[216:219]
    ds_read_b128 v[76:79], v17 offset:8192
    v_mfma_f32_16x16x32_bf16 v[220:223], v[124:127], v[100:103], v[220:223]
    ds_read_b64_tr_b16 v[80:81], v18 offset:32768
    v_mfma_f32_16x16x32_bf16 v[212:215], v[116:119], v[100:103], v[212:215]
    ds_read_b64_tr_b16 v[82:83], v18 offset:33792
    v_mfma_f32_16x16x32_bf16 v[208:211], v[112:115], v[100:103], v[208:211]
    ds_read_b64_tr_b16 v[84:85], v19 offset:32768
    v_mfma_f32_16x16x32_bf16 v[224:227], v[112:115], v[104:107], v[224:227]
    ds_read_b64_tr_b16 v[86:87], v19 offset:33792
    v_mfma_f32_16x16x32_bf16 v[228:231], v[116:119], v[104:107], v[228:231]
    ds_read_b64_tr_b16 v[88:89], v18 offset:40960
    v_mfma_f32_16x16x32_bf16 v[236:239], v[124:127], v[104:107], v[236:239]
    ds_read_b64_tr_b16 v[90:91], v18 offset:41984
    v_mfma_f32_16x16x32_bf16 v[232:235], v[120:123], v[104:107], v[232:235]
    ds_read_b64_tr_b16 v[92:93], v19 offset:40960
    v_mfma_f32_16x16x32_bf16 v[248:251], v[120:123], v[108:111], v[248:251]
    ds_read_b64_tr_b16 v[94:95], v19 offset:41984
    v_mfma_f32_16x16x32_bf16 v[252:255], v[124:127], v[108:111], v[252:255]
    ds_read_b128 v[96:99], v16 offset:16384
    v_mfma_f32_16x16x32_bf16 v[244:247], v[116:119], v[108:111], v[244:247]
    ds_read_b128 v[100:103], v16 offset:24576
    v_mfma_f32_16x16x32_bf16 v[240:243], v[112:115], v[108:111], v[240:243]
    ds_read_b128 v[104:107], v17 offset:16384
    s_waitcnt lgkmcnt(15)
    v_mfma_f32_16x16x32_bf16 v[128:131], v[32:35], v[64:67], v[128:131]
    v_mfma_f32_16x16x32_bf16 v[132:135], v[36:39], v[64:67], v[132:135]
    ds_read_b128 v[108:111], v17 offset:24576
    v_mfma_f32_16x16x32_bf16 v[140:143], v[44:47], v[64:67], v[140:143]
    v_mfma_f32_16x16x32_bf16 v[136:139], v[40:43], v[64:67], v[136:139]
    s_waitcnt lgkmcnt(14)
    v_mfma_f32_16x16x32_bf16 v[128:131], v[48:51], v[68:71], v[128:131]
    ds_read_b128 v[64:67], v16 offset:2048
    v_mfma_f32_16x16x32_bf16 v[132:135], v[52:55], v[68:71], v[132:135]
    v_mfma_f32_16x16x32_bf16 v[140:143], v[60:63], v[68:71], v[140:143]
    v_mfma_f32_16x16x32_bf16 v[136:139], v[56:59], v[68:71], v[136:139]
    s_waitcnt lgkmcnt(14)
    v_mfma_f32_16x16x32_bf16 v[144:147], v[32:35], v[72:75], v[144:147]
    ds_read_b128 v[68:71], v17 offset:2048
    v_mfma_f32_16x16x32_bf16 v[148:151], v[36:39], v[72:75], v[148:151]
    v_mfma_f32_16x16x32_bf16 v[156:159], v[44:47], v[72:75], v[156:159]
    v_mfma_f32_16x16x32_bf16 v[152:155], v[40:43], v[72:75], v[152:155]
    s_waitcnt lgkmcnt(14)
    v_mfma_f32_16x16x32_bf16 v[144:147], v[48:51], v[76:79], v[144:147]
    ds_read_b128 v[72:75], v16 offset:18432
    buffer_load_dword v8, v10, s[44:47], 0 offen sc1
    v_mfma_f32_16x16x32_bf16 v[148:151], v[52:55], v[76:79], v[148:151]
    s_waitcnt lgkmcnt(7)
    v_mfma_f32_16x16x32_bf16 v[156:159], v[60:63], v[76:79], v[156:159]
    s_barrier
    ds_read_b64_tr_b16 v[112:113], v18 offset:49152
    ds_read_b64_tr_b16 v[114:115], v18 offset:50176
    buffer_load_dword v20, v9, s[36:39], 0 offen offset:128 sc1
    v_mfma_f32_16x16x32_bf16 v[152:155], v[56:59], v[76:79], v[152:155]
    ds_read_b64_tr_b16 v[116:117], v19 offset:49152
    ds_read_b64_tr_b16 v[118:119], v19 offset:50176
    s_waitcnt lgkmcnt(10)
    v_mfma_f32_16x16x32_bf16 v[128:131], v[80:83], v[96:99], v[128:131]
    ds_read_b64_tr_b16 v[120:121], v18 offset:57344
    ds_read_b64_tr_b16 v[122:123], v18 offset:58368
    v_mfma_f32_16x16x32_bf16 v[132:135], v[84:87], v[96:99], v[132:135]
    ds_read_b64_tr_b16 v[124:125], v19 offset:57344
    ds_read_b64_tr_b16 v[126:127], v19 offset:58368
    v_mfma_f32_16x16x32_bf16 v[140:143], v[92:95], v[96:99], v[140:143]
    ds_read_b128 v[76:79], v17 offset:18432
    v_mfma_f32_16x16x32_bf16 v[136:139], v[88:91], v[96:99], v[136:139]
    s_waitcnt lgkmcnt(14)
    v_mfma_f32_16x16x32_bf16 v[144:147], v[80:83], v[100:103], v[144:147]
    ds_read_b128 v[96:99], v16 offset:10240
    v_mfma_f32_16x16x32_bf16 v[148:151], v[84:87], v[100:103], v[148:151]
    v_mfma_f32_16x16x32_bf16 v[156:159], v[92:95], v[100:103], v[156:159]
    v_mfma_f32_16x16x32_bf16 v[152:155], v[88:91], v[100:103], v[152:155]
    s_waitcnt lgkmcnt(2)
    v_mfma_f32_16x16x32_bf16 v[128:131], v[112:115], v[104:107], v[128:131]
    ds_read_b128 v[100:103], v17 offset:10240
    v_mfma_f32_16x16x32_bf16 v[132:135], v[116:119], v[104:107], v[132:135]
    ds_write_b32 v15, v15 offset:2048
    v_mfma_f32_16x16x32_bf16 v[140:143], v[124:127], v[104:107], v[140:143]
    v_mfma_f32_16x16x32_bf16 v[136:139], v[120:123], v[104:107], v[136:139]
    v_mfma_f32_16x16x32_bf16 v[144:147], v[112:115], v[108:111], v[144:147]
    ds_read_b128 v[104:107], v16 offset:26624
    v_mfma_f32_16x16x32_bf16 v[148:151], v[116:119], v[108:111], v[148:151]
    v_mfma_f32_16x16x32_bf16 v[156:159], v[124:127], v[108:111], v[156:159]
    v_mfma_f32_16x16x32_bf16 v[152:155], v[120:123], v[108:111], v[152:155]
    v_mfma_f32_16x16x32_bf16 v[160:163], v[32:35], v[64:67], v[160:163]
    ds_read_b128 v[108:111], v17 offset:26624
    v_mfma_f32_16x16x32_bf16 v[164:167], v[36:39], v[64:67], v[164:167]
    v_mfma_f32_16x16x32_bf16 v[172:175], v[44:47], v[64:67], v[172:175]
    v_pk_mul_f32 v[136:137], v[128:129], v[136:137]
    v_pk_mul_f32 v[138:139], v[130:131], v[138:139]
    v_pk_mul_f32 v[140:141], v[132:133], v[140:141]
    v_pk_mul_f32 v[142:143], v[134:135], v[142:143]
    v_pk_mul_f32 v[128:129], s[30:31], v[128:129] op_sel_hi:[0,1]
    v_pk_mul_f32 v[130:131], s[30:31], v[130:131] op_sel_hi:[0,1]
    v_pk_mul_f32 v[132:133], s[30:31], v[132:133] op_sel_hi:[0,1]
    v_pk_mul_f32 v[134:135], s[30:31], v[134:135] op_sel_hi:[0,1]
    v_mfma_f32_16x16x32_bf16 v[168:171], v[40:43], v[64:67], v[168:171]
    v_exp_f32 v128, v128
    v_mfma_f32_16x16x32_bf16 v[160:163], v[48:51], v[68:71], v[160:163]
    ds_read_b128 v[64:67], v16 offset:4096
    v_exp_f32 v129, v129
    v_mfma_f32_16x16x32_bf16 v[164:167], v[52:55], v[68:71], v[164:167]
    v_exp_f32 v130, v130
    v_mfma_f32_16x16x32_bf16 v[172:175], v[60:63], v[68:71], v[172:175]
    v_exp_f32 v131, v131
    v_mfma_f32_16x16x32_bf16 v[168:171], v[56:59], v[68:71], v[168:171]
    v_exp_f32 v132, v132
    v_mfma_f32_16x16x32_bf16 v[160:163], v[80:83], v[72:75], v[160:163]
    ds_read_b128 v[68:71], v17 offset:4096
    v_exp_f32 v133, v133
    v_mfma_f32_16x16x32_bf16 v[164:167], v[84:87], v[72:75], v[164:167]
    v_exp_f32 v134, v134
    v_mfma_f32_16x16x32_bf16 v[172:175], v[92:95], v[72:75], v[172:175]
    v_exp_f32 v135, v135
    v_pk_add_f32 v[128:129], 1.0, v[128:129] op_sel_hi:[0,1]
    v_pk_add_f32 v[130:131], 1.0, v[130:131] op_sel_hi:[0,1]
    v_pk_add_f32 v[132:133], 1.0, v[132:133] op_sel_hi:[0,1]
    v_pk_add_f32 v[134:135], 1.0, v[134:135] op_sel_hi:[0,1]
    v_mfma_f32_16x16x32_bf16 v[168:171], v[88:91], v[72:75], v[168:171]
    v_rcp_f32 v128, v128
    s_waitcnt lgkmcnt(7)
    v_mfma_f32_16x16x32_bf16 v[160:163], v[112:115], v[76:79], v[160:163]
    ds_read_b128 v[72:75], v16 offset:20480
    v_rcp_f32 v129, v129
    v_mfma_f32_16x16x32_bf16 v[164:167], v[116:119], v[76:79], v[164:167]
    v_rcp_f32 v130, v130
    v_mfma_f32_16x16x32_bf16 v[172:175], v[124:127], v[76:79], v[172:175]
    v_rcp_f32 v131, v131
    v_mfma_f32_16x16x32_bf16 v[168:171], v[120:123], v[76:79], v[168:171]
    v_rcp_f32 v132, v132
    s_waitcnt lgkmcnt(7)
    v_mfma_f32_16x16x32_bf16 v[176:179], v[32:35], v[96:99], v[176:179]
    ds_read_b128 v[76:79], v17 offset:20480
    v_rcp_f32 v133, v133
    v_mfma_f32_16x16x32_bf16 v[180:183], v[36:39], v[96:99], v[180:183]
    v_rcp_f32 v134, v134
    v_mfma_f32_16x16x32_bf16 v[188:191], v[44:47], v[96:99], v[188:191]
    v_rcp_f32 v135, v135
    v_pk_mul_f32 v[136:137], v[128:129], v[136:137]
    v_pk_mul_f32 v[138:139], v[130:131], v[138:139]
    v_pk_mul_f32 v[140:141], v[132:133], v[140:141]
    v_pk_mul_f32 v[142:143], v[134:135], v[142:143]
    v_mfma_f32_16x16x32_bf16 v[184:187], v[40:43], v[96:99], v[184:187]
    v_cvt_pk_bf16_f32 v128, v136, v137
    v_cvt_pk_bf16_f32 v129, v138, v139
    s_waitcnt lgkmcnt(7)
    v_mfma_f32_16x16x32_bf16 v[176:179], v[48:51], v[100:103], v[176:179]
    ds_read_b128 v[96:99], v16 offset:12288
    v_cvt_pk_bf16_f32 v130, v140, v141
    v_cvt_pk_bf16_f32 v131, v142, v143
    s_add_u32 s53, s18, 0
    buffer_store_dwordx4 v[128:131], v7, s[32:35], s53 offen sc1
    v_pk_mul_f32 v[152:153], v[144:145], v[152:153]
    v_pk_mul_f32 v[154:155], v[146:147], v[154:155]
    v_pk_mul_f32 v[156:157], v[148:149], v[156:157]
    v_pk_mul_f32 v[158:159], v[150:151], v[158:159]
    v_pk_mul_f32 v[144:145], s[30:31], v[144:145] op_sel_hi:[0,1]
    v_pk_mul_f32 v[146:147], s[30:31], v[146:147] op_sel_hi:[0,1]
    v_pk_mul_f32 v[148:149], s[30:31], v[148:149] op_sel_hi:[0,1]
    v_pk_mul_f32 v[150:151], s[30:31], v[150:151] op_sel_hi:[0,1]
    v_mfma_f32_16x16x32_bf16 v[180:183], v[52:55], v[100:103], v[180:183]
    v_exp_f32 v144, v144
    v_mfma_f32_16x16x32_bf16 v[188:191], v[60:63], v[100:103], v[188:191]
    v_exp_f32 v145, v145
    v_mfma_f32_16x16x32_bf16 v[184:187], v[56:59], v[100:103], v[184:187]
    v_exp_f32 v146, v146
    s_waitcnt lgkmcnt(6)
    v_mfma_f32_16x16x32_bf16 v[176:179], v[80:83], v[104:107], v[176:179]
    ds_read_b128 v[100:103], v17 offset:12288
    v_exp_f32 v147, v147
    v_mfma_f32_16x16x32_bf16 v[180:183], v[84:87], v[104:107], v[180:183]
    v_exp_f32 v148, v148
    v_mfma_f32_16x16x32_bf16 v[188:191], v[92:95], v[104:107], v[188:191]
    v_exp_f32 v149, v149
    v_mfma_f32_16x16x32_bf16 v[184:187], v[88:91], v[104:107], v[184:187]
    v_exp_f32 v150, v150
    s_waitcnt lgkmcnt(6)
    v_mfma_f32_16x16x32_bf16 v[176:179], v[112:115], v[108:111], v[176:179]
    ds_read_b128 v[104:107], v16 offset:28672
    v_exp_f32 v151, v151
    v_pk_add_f32 v[144:145], 1.0, v[144:145] op_sel_hi:[0,1]
    v_pk_add_f32 v[146:147], 1.0, v[146:147] op_sel_hi:[0,1]
    v_pk_add_f32 v[148:149], 1.0, v[148:149] op_sel_hi:[0,1]
    v_pk_add_f32 v[150:151], 1.0, v[150:151] op_sel_hi:[0,1]
    v_mfma_f32_16x16x32_bf16 v[180:183], v[116:119], v[108:111], v[180:183]
    v_rcp_f32 v144, v144
    v_mfma_f32_16x16x32_bf16 v[188:191], v[124:127], v[108:111], v[188:191]
    v_rcp_f32 v145, v145
    v_mfma_f32_16x16x32_bf16 v[184:187], v[120:123], v[108:111], v[184:187]
    v_rcp_f32 v146, v146
    s_waitcnt lgkmcnt(6)
    v_mfma_f32_16x16x32_bf16 v[192:195], v[32:35], v[64:67], v[192:195]
    ds_read_b128 v[108:111], v17 offset:28672
    v_rcp_f32 v147, v147
    v_mfma_f32_16x16x32_bf16 v[196:199], v[36:39], v[64:67], v[196:199]
    v_rcp_f32 v148, v148
    v_mfma_f32_16x16x32_bf16 v[204:207], v[44:47], v[64:67], v[204:207]
    v_rcp_f32 v149, v149
    v_mfma_f32_16x16x32_bf16 v[200:203], v[40:43], v[64:67], v[200:203]
    v_rcp_f32 v150, v150
    s_waitcnt lgkmcnt(6)
    v_mfma_f32_16x16x32_bf16 v[192:195], v[48:51], v[68:71], v[192:195]
    ds_read_b128 v[64:67], v16 offset:6144
    v_rcp_f32 v151, v151
    v_pk_mul_f32 v[152:153], v[144:145], v[152:153]
    v_pk_mul_f32 v[154:155], v[146:147], v[154:155]
    v_pk_mul_f32 v[156:157], v[148:149], v[156:157]
    v_pk_mul_f32 v[158:159], v[150:151], v[158:159]
    v_mfma_f32_16x16x32_bf16 v[196:199], v[52:55], v[68:71], v[196:199]
    v_cvt_pk_bf16_f32 v144, v152, v153
    v_cvt_pk_bf16_f32 v145, v154, v155
    v_mfma_f32_16x16x32_bf16 v[204:207], v[60:63], v[68:71], v[204:207]
    v_cvt_pk_bf16_f32 v146, v156, v157
    v_cvt_pk_bf16_f32 v147, v158, v159
    s_add_u32 s53, s18, 475136
    buffer_store_dwordx4 v[144:147], v7, s[32:35], s53 offen sc1
    v_pk_mul_f32 v[168:169], v[160:161], v[168:169]
    v_pk_mul_f32 v[170:171], v[162:163], v[170:171]
    v_pk_mul_f32 v[172:173], v[164:165], v[172:173]
    v_pk_mul_f32 v[174:175], v[166:167], v[174:175]
    v_pk_mul_f32 v[160:161], s[30:31], v[160:161] op_sel_hi:[0,1]
    v_pk_mul_f32 v[162:163], s[30:31], v[162:163] op_sel_hi:[0,1]
    v_pk_mul_f32 v[164:165], s[30:31], v[164:165] op_sel_hi:[0,1]
    v_pk_mul_f32 v[166:167], s[30:31], v[166:167] op_sel_hi:[0,1]
    v_mfma_f32_16x16x32_bf16 v[200:203], v[56:59], v[68:71], v[200:203]
    v_exp_f32 v160, v160
    s_waitcnt lgkmcnt(6)
    v_mfma_f32_16x16x32_bf16 v[192:195], v[80:83], v[72:75], v[192:195]
    ds_read_b128 v[68:71], v17 offset:6144
    v_exp_f32 v161, v161
    v_mfma_f32_16x16x32_bf16 v[196:199], v[84:87], v[72:75], v[196:199]
    v_exp_f32 v162, v162
    v_mfma_f32_16x16x32_bf16 v[204:207], v[92:95], v[72:75], v[204:207]
    v_exp_f32 v163, v163
    v_mfma_f32_16x16x32_bf16 v[200:203], v[88:91], v[72:75], v[200:203]
    v_exp_f32 v164, v164
    s_waitcnt lgkmcnt(6)
    v_mfma_f32_16x16x32_bf16 v[192:195], v[112:115], v[76:79], v[192:195]
    ds_read_b128 v[72:75], v16 offset:22528
    v_exp_f32 v165, v165
    v_mfma_f32_16x16x32_bf16 v[196:199], v[116:119], v[76:79], v[196:199]
    v_exp_f32 v166, v166
    v_mfma_f32_16x16x32_bf16 v[204:207], v[124:127], v[76:79], v[204:207]
    v_exp_f32 v167, v167
    v_pk_add_f32 v[160:161], 1.0, v[160:161] op_sel_hi:[0,1]
    v_pk_add_f32 v[162:163], 1.0, v[162:163] op_sel_hi:[0,1]
    v_pk_add_f32 v[164:165], 1.0, v[164:165] op_sel_hi:[0,1]
    v_pk_add_f32 v[166:167], 1.0, v[166:167] op_sel_hi:[0,1]
    v_mfma_f32_16x16x32_bf16 v[200:203], v[120:123], v[76:79], v[200:203]
    v_rcp_f32 v160, v160
    s_waitcnt lgkmcnt(6)
    v_mfma_f32_16x16x32_bf16 v[208:211], v[32:35], v[96:99], v[208:211]
    ds_read_b128 v[76:79], v17 offset:22528
    v_rcp_f32 v161, v161
    v_mfma_f32_16x16x32_bf16 v[212:215], v[36:39], v[96:99], v[212:215]
    v_rcp_f32 v162, v162
    v_mfma_f32_16x16x32_bf16 v[220:223], v[44:47], v[96:99], v[220:223]
    v_rcp_f32 v163, v163
    v_mfma_f32_16x16x32_bf16 v[216:219], v[40:43], v[96:99], v[216:219]
    v_rcp_f32 v164, v164
    s_waitcnt lgkmcnt(6)
    v_mfma_f32_16x16x32_bf16 v[208:211], v[48:51], v[100:103], v[208:211]
    ds_read_b128 v[96:99], v16 offset:14336
    v_rcp_f32 v165, v165
    v_mfma_f32_16x16x32_bf16 v[212:215], v[52:55], v[100:103], v[212:215]
    v_rcp_f32 v166, v166
    v_mfma_f32_16x16x32_bf16 v[220:223], v[60:63], v[100:103], v[220:223]
    v_rcp_f32 v167, v167
    v_pk_mul_f32 v[168:169], v[160:161], v[168:169]
    v_pk_mul_f32 v[170:171], v[162:163], v[170:171]
    v_pk_mul_f32 v[172:173], v[164:165], v[172:173]
    v_pk_mul_f32 v[174:175], v[166:167], v[174:175]
    v_mfma_f32_16x16x32_bf16 v[216:219], v[56:59], v[100:103], v[216:219]
    v_cvt_pk_bf16_f32 v160, v168, v169
    v_cvt_pk_bf16_f32 v161, v170, v171
    s_waitcnt lgkmcnt(6)
    v_mfma_f32_16x16x32_bf16 v[208:211], v[80:83], v[104:107], v[208:211]
    ds_read_b128 v[100:103], v17 offset:14336
    v_cvt_pk_bf16_f32 v162, v172, v173
    v_cvt_pk_bf16_f32 v163, v174, v175
    s_add_u32 s53, s18, 118784
    buffer_store_dwordx4 v[160:163], v7, s[32:35], s53 offen sc1
    ds_write_b32 v15, v15
    v_pk_mul_f32 v[184:185], v[176:177], v[184:185]
    v_pk_mul_f32 v[186:187], v[178:179], v[186:187]
    v_pk_mul_f32 v[188:189], v[180:181], v[188:189]
    v_pk_mul_f32 v[190:191], v[182:183], v[190:191]
    v_pk_mul_f32 v[176:177], s[30:31], v[176:177] op_sel_hi:[0,1]
    v_pk_mul_f32 v[178:179], s[30:31], v[178:179] op_sel_hi:[0,1]
    v_pk_mul_f32 v[180:181], s[30:31], v[180:181] op_sel_hi:[0,1]
    v_pk_mul_f32 v[182:183], s[30:31], v[182:183] op_sel_hi:[0,1]
    v_mfma_f32_16x16x32_bf16 v[212:215], v[84:87], v[104:107], v[212:215]
    v_exp_f32 v176, v176
    v_mfma_f32_16x16x32_bf16 v[220:223], v[92:95], v[104:107], v[220:223]
    v_exp_f32 v177, v177
    v_mfma_f32_16x16x32_bf16 v[216:219], v[88:91], v[104:107], v[216:219]
    v_exp_f32 v178, v178
    s_waitcnt lgkmcnt(7)
    v_mfma_f32_16x16x32_bf16 v[208:211], v[112:115], v[108:111], v[208:211]
    ds_read_b128 v[104:107], v16 offset:30720
    v_exp_f32 v179, v179
    v_mfma_f32_16x16x32_bf16 v[212:215], v[116:119], v[108:111], v[212:215]
    v_exp_f32 v180, v180
    v_mfma_f32_16x16x32_bf16 v[220:223], v[124:127], v[108:111], v[220:223]
    v_exp_f32 v181, v181
    v_mfma_f32_16x16x32_bf16 v[216:219], v[120:123], v[108:111], v[216:219]
    v_exp_f32 v182, v182
    s_waitcnt lgkmcnt(7)
    v_mfma_f32_16x16x32_bf16 v[224:227], v[32:35], v[64:67], v[224:227]
    ds_read_b128 v[108:111], v17 offset:30720
    v_exp_f32 v183, v183
    v_pk_add_f32 v[176:177], 1.0, v[176:177] op_sel_hi:[0,1]
    v_pk_add_f32 v[178:179], 1.0, v[178:179] op_sel_hi:[0,1]
    v_pk_add_f32 v[180:181], 1.0, v[180:181] op_sel_hi:[0,1]
    v_pk_add_f32 v[182:183], 1.0, v[182:183] op_sel_hi:[0,1]
    v_mfma_f32_16x16x32_bf16 v[228:231], v[36:39], v[64:67], v[228:231]
    v_rcp_f32 v176, v176
    v_mfma_f32_16x16x32_bf16 v[236:239], v[44:47], v[64:67], v[236:239]
    v_rcp_f32 v177, v177
    v_mfma_f32_16x16x32_bf16 v[232:235], v[40:43], v[64:67], v[232:235]
    v_rcp_f32 v178, v178
    s_waitcnt lgkmcnt(7)
    v_mfma_f32_16x16x32_bf16 v[224:227], v[48:51], v[68:71], v[224:227]
    v_rcp_f32 v179, v179
    v_mfma_f32_16x16x32_bf16 v[228:231], v[52:55], v[68:71], v[228:231]
    v_rcp_f32 v180, v180
    v_mfma_f32_16x16x32_bf16 v[236:239], v[60:63], v[68:71], v[236:239]
    v_rcp_f32 v181, v181
    v_mfma_f32_16x16x32_bf16 v[232:235], v[56:59], v[68:71], v[232:235]
    v_rcp_f32 v182, v182
    s_waitcnt lgkmcnt(6)
    v_mfma_f32_16x16x32_bf16 v[224:227], v[80:83], v[72:75], v[224:227]
    v_rcp_f32 v183, v183
    v_pk_mul_f32 v[184:185], v[176:177], v[184:185]
    v_pk_mul_f32 v[186:187], v[178:179], v[186:187]
    v_pk_mul_f32 v[188:189], v[180:181], v[188:189]
    v_pk_mul_f32 v[190:191], v[182:183], v[190:191]
    v_mfma_f32_16x16x32_bf16 v[228:231], v[84:87], v[72:75], v[228:231]
    v_cvt_pk_bf16_f32 v176, v184, v185
    v_cvt_pk_bf16_f32 v177, v186, v187
    v_mfma_f32_16x16x32_bf16 v[236:239], v[92:95], v[72:75], v[236:239]
    v_cvt_pk_bf16_f32 v178, v188, v189
    v_cvt_pk_bf16_f32 v179, v190, v191
    s_add_u32 s53, s18, 593920
    buffer_store_dwordx4 v[176:179], v7, s[32:35], s53 offen sc1
    v_pk_mul_f32 v[200:201], v[192:193], v[200:201]
    v_pk_mul_f32 v[202:203], v[194:195], v[202:203]
    v_pk_mul_f32 v[204:205], v[196:197], v[204:205]
    v_pk_mul_f32 v[206:207], v[198:199], v[206:207]
    v_pk_mul_f32 v[192:193], s[30:31], v[192:193] op_sel_hi:[0,1]
    v_pk_mul_f32 v[194:195], s[30:31], v[194:195] op_sel_hi:[0,1]
    v_pk_mul_f32 v[196:197], s[30:31], v[196:197] op_sel_hi:[0,1]
    v_pk_mul_f32 v[198:199], s[30:31], v[198:199] op_sel_hi:[0,1]
    v_mfma_f32_16x16x32_bf16 v[232:235], v[88:91], v[72:75], v[232:235]
    v_exp_f32 v192, v192
    s_waitcnt lgkmcnt(5)
    v_mfma_f32_16x16x32_bf16 v[224:227], v[112:115], v[76:79], v[224:227]
    v_exp_f32 v193, v193
    v_mfma_f32_16x16x32_bf16 v[228:231], v[116:119], v[76:79], v[228:231]
    v_exp_f32 v194, v194
    v_mfma_f32_16x16x32_bf16 v[236:239], v[124:127], v[76:79], v[236:239]
    v_exp_f32 v195, v195
    v_mfma_f32_16x16x32_bf16 v[232:235], v[120:123], v[76:79], v[232:235]
    v_exp_f32 v196, v196
    s_waitcnt lgkmcnt(4)
    v_mfma_f32_16x16x32_bf16 v[240:243], v[32:35], v[96:99], v[240:243]
    v_exp_f32 v197, v197
    v_mfma_f32_16x16x32_bf16 v[244:247], v[36:39], v[96:99], v[244:247]
    v_exp_f32 v198, v198
    v_mfma_f32_16x16x32_bf16 v[252:255], v[44:47], v[96:99], v[252:255]
    v_exp_f32 v199, v199
    v_pk_add_f32 v[192:193], 1.0, v[192:193] op_sel_hi:[0,1]
    v_pk_add_f32 v[194:195], 1.0, v[194:195] op_sel_hi:[0,1]
    v_pk_add_f32 v[196:197], 1.0, v[196:197] op_sel_hi:[0,1]
    v_pk_add_f32 v[198:199], 1.0, v[198:199] op_sel_hi:[0,1]
    v_mfma_f32_16x16x32_bf16 v[248:251], v[40:43], v[96:99], v[248:251]
    v_rcp_f32 v192, v192
    s_waitcnt lgkmcnt(3)
    v_mfma_f32_16x16x32_bf16 v[240:243], v[48:51], v[100:103], v[240:243]
    v_rcp_f32 v193, v193
    v_mfma_f32_16x16x32_bf16 v[244:247], v[52:55], v[100:103], v[244:247]
    v_rcp_f32 v194, v194
    v_mfma_f32_16x16x32_bf16 v[252:255], v[60:63], v[100:103], v[252:255]
    v_rcp_f32 v195, v195
    v_mfma_f32_16x16x32_bf16 v[248:251], v[56:59], v[100:103], v[248:251]
    v_rcp_f32 v196, v196
L_PAD_comp.8:
    s_cbranch_execz L_DISP
    s_waitcnt lgkmcnt(1)
    v_mfma_f32_16x16x32_bf16 v[240:243], v[80:83], v[104:107], v[240:243]
    v_rcp_f32 v197, v197
    v_mfma_f32_16x16x32_bf16 v[244:247], v[84:87], v[104:107], v[244:247]
    v_rcp_f32 v198, v198
    v_mfma_f32_16x16x32_bf16 v[252:255], v[92:95], v[104:107], v[252:255]
    v_rcp_f32 v199, v199
    v_pk_mul_f32 v[200:201], v[192:193], v[200:201]
    v_pk_mul_f32 v[202:203], v[194:195], v[202:203]
    v_pk_mul_f32 v[204:205], v[196:197], v[204:205]
    v_pk_mul_f32 v[206:207], v[198:199], v[206:207]
    v_mfma_f32_16x16x32_bf16 v[248:251], v[88:91], v[104:107], v[248:251]
    v_cvt_pk_bf16_f32 v192, v200, v201
    v_cvt_pk_bf16_f32 v193, v202, v203
    s_waitcnt lgkmcnt(0)
    v_mfma_f32_16x16x32_bf16 v[240:243], v[112:115], v[108:111], v[240:243]
    v_cvt_pk_bf16_f32 v194, v204, v205
    v_cvt_pk_bf16_f32 v195, v206, v207
    v_pk_mul_f32 v[216:217], v[208:209], v[216:217]
    v_pk_mul_f32 v[218:219], v[210:211], v[218:219]
    v_pk_mul_f32 v[220:221], v[212:213], v[220:221]
    v_pk_mul_f32 v[222:223], v[214:215], v[222:223]
    v_pk_mul_f32 v[208:209], s[30:31], v[208:209] op_sel_hi:[0,1]
    v_pk_mul_f32 v[210:211], s[30:31], v[210:211] op_sel_hi:[0,1]
    v_pk_mul_f32 v[212:213], s[30:31], v[212:213] op_sel_hi:[0,1]
    v_pk_mul_f32 v[214:215], s[30:31], v[214:215] op_sel_hi:[0,1]
    v_mfma_f32_16x16x32_bf16 v[244:247], v[116:119], v[108:111], v[244:247]
    v_exp_f32 v208, v208
    v_mfma_f32_16x16x32_bf16 v[252:255], v[124:127], v[108:111], v[252:255]
    v_exp_f32 v209, v209
    v_mfma_f32_16x16x32_bf16 v[248:251], v[120:123], v[108:111], v[248:251]
    v_exp_f32 v210, v210
    v_exp_f32 v211, v211
    v_exp_f32 v212, v212
    v_exp_f32 v213, v213
    v_exp_f32 v214, v214
    v_exp_f32 v215, v215
    v_pk_add_f32 v[208:209], 1.0, v[208:209] op_sel_hi:[0,1]
    v_pk_add_f32 v[210:211], 1.0, v[210:211] op_sel_hi:[0,1]
    v_pk_add_f32 v[212:213], 1.0, v[212:213] op_sel_hi:[0,1]
    v_pk_add_f32 v[214:215], 1.0, v[214:215] op_sel_hi:[0,1]
    v_rcp_f32 v208, v208
    v_rcp_f32 v209, v209
    v_rcp_f32 v210, v210
    v_rcp_f32 v211, v211
    v_rcp_f32 v212, v212
    v_rcp_f32 v213, v213
    v_rcp_f32 v214, v214
    v_rcp_f32 v215, v215
    v_pk_mul_f32 v[216:217], v[208:209], v[216:217]
    v_pk_mul_f32 v[218:219], v[210:211], v[218:219]
    v_pk_mul_f32 v[220:221], v[212:213], v[220:221]
    v_pk_mul_f32 v[222:223], v[214:215], v[222:223]
    v_cvt_pk_bf16_f32 v208, v216, v217
    v_cvt_pk_bf16_f32 v209, v218, v219
    v_cvt_pk_bf16_f32 v210, v220, v221
    v_cvt_pk_bf16_f32 v211, v222, v223
    v_pk_mul_f32 v[232:233], v[224:225], v[232:233]
    v_pk_mul_f32 v[234:235], v[226:227], v[234:235]
    v_pk_mul_f32 v[236:237], v[228:229], v[236:237]
    v_pk_mul_f32 v[238:239], v[230:231], v[238:239]
    v_pk_mul_f32 v[224:225], s[30:31], v[224:225] op_sel_hi:[0,1]
    v_pk_mul_f32 v[226:227], s[30:31], v[226:227] op_sel_hi:[0,1]
    v_pk_mul_f32 v[228:229], s[30:31], v[228:229] op_sel_hi:[0,1]
    v_pk_mul_f32 v[230:231], s[30:31], v[230:231] op_sel_hi:[0,1]
    v_exp_f32 v224, v224
    v_exp_f32 v225, v225
    v_exp_f32 v226, v226
    v_exp_f32 v227, v227
    v_exp_f32 v228, v228
    v_exp_f32 v229, v229
    v_exp_f32 v230, v230
    v_exp_f32 v231, v231
    v_pk_add_f32 v[224:225], 1.0, v[224:225] op_sel_hi:[0,1]
    v_pk_add_f32 v[226:227], 1.0, v[226:227] op_sel_hi:[0,1]
    v_pk_add_f32 v[228:229], 1.0, v[228:229] op_sel_hi:[0,1]
    v_pk_add_f32 v[230:231], 1.0, v[230:231] op_sel_hi:[0,1]
    v_rcp_f32 v224, v224
    v_rcp_f32 v225, v225
    v_rcp_f32 v226, v226
    v_rcp_f32 v227, v227
    v_rcp_f32 v228, v228
    v_rcp_f32 v229, v229
    v_rcp_f32 v230, v230
    v_rcp_f32 v231, v231
    v_pk_mul_f32 v[232:233], v[224:225], v[232:233]
    v_pk_mul_f32 v[234:235], v[226:227], v[234:235]
    v_pk_mul_f32 v[236:237], v[228:229], v[236:237]
    v_pk_mul_f32 v[238:239], v[230:231], v[238:239]
    v_cvt_pk_bf16_f32 v224, v232, v233
    v_cvt_pk_bf16_f32 v225, v234, v235
    v_cvt_pk_bf16_f32 v226, v236, v237
    v_cvt_pk_bf16_f32 v227, v238, v239
    ds_read_b32 v23, v21 offset:2048
    ds_read_b32 v26, v15 offset:3072
    v_pk_mul_f32 v[248:249], v[240:241], v[248:249]
    v_pk_mul_f32 v[250:251], v[242:243], v[250:251]
    v_pk_mul_f32 v[252:253], v[244:245], v[252:253]
    v_pk_mul_f32 v[254:255], v[246:247], v[254:255]
    v_pk_mul_f32 v[240:241], s[30:31], v[240:241] op_sel_hi:[0,1]
    v_pk_mul_f32 v[242:243], s[30:31], v[242:243] op_sel_hi:[0,1]
    v_pk_mul_f32 v[244:245], s[30:31], v[244:245] op_sel_hi:[0,1]
    v_pk_mul_f32 v[246:247], s[30:31], v[246:247] op_sel_hi:[0,1]
    v_exp_f32 v240, v240
    v_exp_f32 v241, v241
    v_exp_f32 v242, v242
    v_exp_f32 v243, v243
    v_exp_f32 v244, v244
    v_exp_f32 v245, v245
    v_exp_f32 v246, v246
    v_exp_f32 v247, v247
    v_pk_add_f32 v[240:241], 1.0, v[240:241] op_sel_hi:[0,1]
    v_pk_add_f32 v[242:243], 1.0, v[242:243] op_sel_hi:[0,1]
    v_pk_add_f32 v[244:245], 1.0, v[244:245] op_sel_hi:[0,1]
    v_pk_add_f32 v[246:247], 1.0, v[246:247] op_sel_hi:[0,1]
    v_rcp_f32 v240, v240
    v_rcp_f32 v241, v241
    v_rcp_f32 v242, v242
    v_rcp_f32 v243, v243
    v_rcp_f32 v244, v244
    v_rcp_f32 v245, v245
    v_rcp_f32 v246, v246
    v_rcp_f32 v247, v247
    v_pk_mul_f32 v[248:249], v[240:241], v[248:249]
    v_pk_mul_f32 v[250:251], v[242:243], v[250:251]
    v_pk_mul_f32 v[252:253], v[244:245], v[252:253]
    v_pk_mul_f32 v[254:255], v[246:247], v[254:255]
    v_cvt_pk_bf16_f32 v240, v248, v249
    v_cvt_pk_bf16_f32 v241, v250, v251
    v_cvt_pk_bf16_f32 v242, v252, v253
    v_cvt_pk_bf16_f32 v243, v254, v255
    s_waitcnt vmcnt(4)
    v_readfirstlane_b32 s61, v8
    s_mov_b32 s54, 0x100000
    s_cmp_eq_u32 s61, 0
    s_cbranch_scc1 L_GD
    v_cmp_ne_u32 vcc, s61, v20
    s_and_b32 vcc_lo, vcc_lo, 0x3fff
    s_cbranch_scc1 L_GD
L_GDR:
    s_waitcnt lgkmcnt(0)
    v_min_u32 v23, v23, v26
    v_cmp_eq_u32 vcc, 0, v23
    s_cbranch_vccz L_GDX
    ds_read_b32 v23, v21 offset:2048
    ds_read_b32 v26, v15 offset:3072
    s_sub_u32 s54, s54, 1
    s_cbranch_scc0 L_GDR
    s_waitcnt lgkmcnt(0)
L_GDX:
    s_add_u32 m0, s60, 77824
    s_add_u32 s53, s71, 475136
    buffer_load_dwordx4 v7, s[36:39], s53 offen sc1 lds
    s_add_u32 m0, s60, 81920
    s_add_u32 s53, s72, 475136
    buffer_load_dwordx4 v7, s[36:39], s53 offen sc1 lds
    s_add_u32 m0, s60, 86016
    s_add_u32 s53, s73, 475136
    buffer_load_dwordx4 v7, s[36:39], s53 offen sc1 lds
    s_add_u32 m0, s60, 90112
    s_add_u32 s53, s74, 475136
    buffer_load_dwordx4 v7, s[36:39], s53 offen sc1 lds
    s_add_u32 m0, s60, 94208
    s_add_u32 s53, s75, 475136
    buffer_load_dwordx4 v7, s[36:39], s53 offen sc1 lds
    s_add_u32 m0, s60, 98304
    s_add_u32 s53, s76, 475136
    buffer_load_dwordx4 v7, s[36:39], s53 offen sc1 lds
    s_add_u32 m0, s60, 102400
    s_add_u32 s53, s77, 475136
    buffer_load_dwordx4 v7, s[36:39], s53 offen sc1 lds
    s_setprio 0
    s_add_u32 s53, s18, 237568
    buffer_store_dwordx4 v[192:195], v7, s[32:35], s53 offen sc1
    s_add_u32 s53, s18, 712704
    buffer_store_dwordx4 v[208:211], v7, s[32:35], s53 offen sc1
    s_waitcnt vmcnt(2)
    ds_read_b32 v64, v11 offset:28672
    ds_read_b32 v65, v11 offset:32768
    ds_read_b32 v66, v11 offset:36864
    ds_read_b32 v67, v11 offset:40960
    ds_read_b32 v68, v11 offset:45056
    ds_read_b32 v69, v11 offset:49152
    ds_read_b32 v70, v11 offset:53248
    v_mov_b32 v5, s61
    s_mov_b64 exec, 1
    buffer_store_dword v5, v10, s[32:35], s19 offen sc1
    s_mov_b64 exec, -1
    s_add_u32 s53, s18, 356352
    buffer_store_dwordx4 v[224:227], v7, s[32:35], s53 offen sc1
    s_add_u32 s53, s18, 831488
    buffer_store_dwordx4 v[240:243], v7, s[32:35], s53 offen sc1
    s_waitcnt lgkmcnt(0)
    v_max3_u32 v3, v64, v65, v66
    v_max3_u32 v4, v67, v68, v69
    v_max3_u32 v3, v3, v4, v70
    v_cmp_eq_u32 vcc, -1, v3
    s_movk_i32 s62, 400
    s_cbranch_vccnz L_RC1
L_OKC1:
    s_branch L_P2H
    .fill 15, 4, 0xbf810000
L_SPARE:
    s_lshl_b32 s54, s56, 3
    s_add_u32 s54, s54, s48
    s_lshl_b32 s55, s53, 2
    s_add_u32 s55, s55, s56
    v_mul_u32_u24 v3, 37, v2
    v_lshrrev_b32 v3, 8, v3
    v_mul_u32_u24 v4, 7, v3
    v_sub_u32 v4, v2, v4
    s_lshr_b32 s57, s54, 1
    s_mul_i32 s57, s57, 9
    s_add_u32 s57, s57, 288
    v_add_u32 v3, s57, v3
    s_movk_i32 s57, 7168
    v_mul_lo_u32 v3, v3, s57
    s_mul_i32 s57, s53, 7
    v_add_u32 v4, s57, v4
    v_lshl_add_u32 v11, v4, 7, v3
    s_lshr_b32 s57, s55, 1
    s_lshl_b32 s57, s57, 17
    s_and_b32 s58, s55, 1
    s_lshl_b32 s58, s58, 7
    s_add_u32 s57, s57, s58
    s_lshl_b32 s58, s48, 8
    s_add_u32 s57, s57, s58
    v_lshlrev_b32 v12, 11, v2
    v_add_u32 v12, s57, v12
    v_mov_b32 v10, 0
    s_waitcnt lgkmcnt(0)
    s_mov_b32 s20, s4
    s_and_b32 s21, s5, 0xffff
    s_mov_b32 s22, 2097152
    s_mov_b32 s23, 0x00020000
    s_mov_b32 s24, s6
    s_and_b32 s25, s7, 0xffff
    s_mov_b32 s26, 7340032
    s_mov_b32 s27, 0x00020000
    s_bitcmp0_b32 s54, 0
    s_cbranch_scc1 L_SPG
    s_mov_b32 s24, s8
    s_and_b32 s25, s9, 0xffff
    s_mov_b32 s26, 7340032
    s_mov_b32 s27, 0x00020000
L_SPG:
    s_mov_b32 s44, s14
    s_and_b32 s45, s15, 0xffff
    s_mov_b32 s46, 256
    s_mov_b32 s47, 0x00020000
    s_cmp_ge_u32 s48, 3
    s_cbranch_scc1 L_SPX0
    buffer_load_dword v13, v12, s[20:23], 0 offen
L_SPX0:
    buffer_load_dword v14, v11, s[24:27], 0 offen
    s_xor_b32 s57, s2, 56
    s_or_b32 s57, s57, s48
    s_cmp_lg_u32 s57, 0
    s_cbranch_scc1 L_SP1
    s_memrealtime s[56:57]
    s_mov_b32 s58, 0x01010101
    s_waitcnt lgkmcnt(0)
    s_bfe_u32 s57, s56, 0x70000
    s_lshl_b32 s57, s57, 1
    s_or_b32 s58, s58, s57
    s_bfe_u32 s57, s56, 0x70007
    s_lshl_b32 s57, s57, 9
    s_or_b32 s58, s58, s57
    s_bfe_u32 s57, s56, 0x7000e
    s_lshl_b32 s57, s57, 17
    s_or_b32 s58, s58, s57
    s_bfe_u32 s57, s56, 0x70015
    s_lshl_b32 s57, s57, 25
    s_or_b32 s58, s58, s57
    v_mov_b32 v3, s58
    s_mov_b64 exec, 1
    buffer_store_dword v3, v10, s[44:47], 0 offen sc1
    s_mov_b64 exec, -1
L_SP1:
    s_cmp_lt_u32 s48, 3
    s_cbranch_scc1 L_SPX1
    buffer_load_dword v13, v12, s[20:23], 0 offen
L_SPX1:
    s_mov_b32 s32, s10
    s_and_b32 s33, s11, 0xffff
    s_mov_b32 s34, 7340032
    s_mov_b32 s35, 0x00020000
    s_mov_b32 s36, s16
    s_and_b32 s37, s17, 0xffff
    s_mov_b32 s38, 268435456
    s_mov_b32 s39, 0x00020000
    s_mov_b32 s40, s12
    s_and_b32 s41, s13, 0xffff
    s_mov_b32 s42, 2097152
    s_mov_b32 s43, 0x00020000
    s_mov_b32 s57, 1032192
    s_waitcnt vmcnt(1)
    buffer_load_dword v14, v11, s[24:27], s57 offen
    s_mov_b32 s57, 2064384
    s_waitcnt vmcnt(1)
    buffer_load_dword v14, v11, s[24:27], s57 offen
    s_mov_b32 s57, 3096576
    s_waitcnt vmcnt(1)
    buffer_load_dword v14, v11, s[24:27], s57 offen
    s_mov_b32 s57, 4128768
    s_waitcnt vmcnt(1)
    buffer_load_dword v14, v11, s[24:27], s57 offen
    s_mov_b32 s57, 5160960
    s_waitcnt vmcnt(1)
    buffer_load_dword v14, v11, s[24:27], s57 offen
L_SP2:
    s_lshl_b32 s60, s48, 10
    s_and_b32 s60, s60, 3072
    v_lshlrev_b32 v7, 4, v2
    v_mov_b32 v10, 0
    v_lshrrev_b32 v3, 3, v2
    v_and_b32 v4, 6, v3
    v_lshlrev_b32 v3, 11, v3
    v_and_b32 v5, 7, v2
    v_xor_b32 v4, v4, v5
    v_lshl_add_u32 v3, v4, 4, v3
    s_and_b32 s53, s48, 2
    s_lshl_b32 s53, s53, 16
    s_and_b32 s54, s48, 1
    s_lshl_b32 s54, s54, 7
    s_add_u32 s53, s53, s54
    v_add_u32 v6, s53, v3
    s_mul_i32 s54, s59, 1835008
    s_lshl_b32 s53, s50, 8
    s_add_u32 s54, s54, s53
    s_mul_i32 s7, s49, 954368
    s_mul_i32 s53, s59, 28672
    s_add_u32 s7, s7, s53
    s_add_u32 s7, s7, s60
    s_add_u32 s7, s7, 65536
    s_mov_b32 s3, s7
    s_and_b32 s53, s50, 3
    s_mul_i32 s53, s53, 0
    s_add_u32 s53, s53, s49
    s_sub_u32 s8, s53, 7
    s_cselect_b32 s53, s53, s8
    s_lshl_b32 s8, s53, 18
    s_add_u32 s64, s54, s8
    s_mul_i32 s8, s53, 4096
    s_add_u32 s71, s8, s7
    s_add_u32 s53, s53, 1
    s_cmp_eq_u32 s53, 7
    s_cselect_b32 s53, 0, s53
    s_lshl_b32 s8, s53, 18
    s_add_u32 s65, s54, s8
    s_mul_i32 s8, s53, 4096
    s_add_u32 s72, s8, s7
    s_add_u32 s53, s53, 1
    s_cmp_eq_u32 s53, 7
    s_cselect_b32 s53, 0, s53
    s_lshl_b32 s8, s53, 18
    s_add_u32 s66, s54, s8
    s_mul_i32 s8, s53, 4096
    s_add_u32 s73, s8, s7
    s_add_u32 s53, s53, 1
    s_cmp_eq_u32 s53, 7
    s_cselect_b32 s53, 0, s53
    s_lshl_b32 s8, s53, 18
    s_add_u32 s67, s54, s8
    s_mul_i32 s8, s53, 4096
    s_add_u32 s74, s8, s7
    s_add_u32 s53, s53, 1
    s_cmp_eq_u32 s53, 7
    s_cselect_b32 s53, 0, s53
    s_lshl_b32 s8, s53, 18
    s_add_u32 s68, s54, s8
    s_mul_i32 s8, s53, 4096
    s_add_u32 s75, s8, s7
    s_add_u32 s53, s53, 1
    s_cmp_eq_u32 s53, 7
    s_cselect_b32 s53, 0, s53
    s_lshl_b32 s8, s53, 18
    s_add_u32 s69, s54, s8
    s_mul_i32 s8, s53, 4096
    s_add_u32 s76, s8, s7
    s_add_u32 s53, s53, 1
    s_cmp_eq_u32 s53, 7
    s_cselect_b32 s53, 0, s53
    s_lshl_b32 s8, s53, 18
    s_add_u32 s70, s54, s8
    s_mul_i32 s8, s53, 4096
    s_add_u32 s77, s8, s7
    s_movk_i32 s11, 0xff
    s_lshl_b32 s53, s49, 2
    s_add_u32 s53, s53, s59
    s_lshl_b32 s53, s53, 9
    s_and_b32 s54, s48, 2
    s_lshl_b32 s54, s54, 7
    s_add_u32 s53, s53, s54
    s_add_u32 s14, s53, 14680064
    v_lshlrev_b32 v3, 2, v2
    v_add_u32 v9, s14, v3
    s_lshl_b32 s7, s49, 3
    s_add_u32 s7, s7, s50
    s_mul_i32 s7, s7, 196608
    s_lshl_b32 s54, s60, 1
    s_add_u32 s7, s7, s54
    s_add_u32 s7, s7, 16777216
    s_add_u32 s53, s59, 1
    s_and_b32 s53, s53, 3
    s_mul_i32 s53, s53, 49152
    s_add_u32 s53, s53, 0
    s_add_u32 s4, s53, s7
    s_add_u32 s53, s59, 2
    s_and_b32 s53, s53, 3
    s_mul_i32 s53, s53, 49152
    s_add_u32 s53, s53, 16384
    s_add_u32 s5, s53, s7
    s_add_u32 s53, s59, 3
    s_and_b32 s53, s53, 3
    s_mul_i32 s53, s53, 49152
    s_add_u32 s53, s53, 32768
    s_add_u32 s6, s53, s7
    s_mul_i32 s54, s59, 49152
    s_add_u32 s7, s7, s54
    s_lshl_b32 s53, s49, 3
    s_add_u32 s53, s53, s59
    s_lshl_b32 s8, s53, 15
    s_lshl_b32 s53, s50, 8
    s_add_u32 s8, s8, s53
    s_and_b32 s53, s48, 1
    s_lshl_b32 s53, s53, 7
    s_add_u32 s8, s8, s53
    s_and_b32 s53, s48, 2
    s_lshl_b32 s53, s53, 5
    s_add_u32 s8, s8, s53
    s_lshr_b32 s53, s60, 2
    s_add_u32 s53, s53, 45056
    v_lshlrev_b32 v15, 2, v2
    v_add_u32 v15, s53, v15
    buffer_load_dword v8, v10, s[44:47], 0 offen sc1
    s_cmp_ge_u32 s48, 4
    s_cbranch_scc1 L_SPM
    s_waitcnt vmcnt(0)
    s_mov_b32 s32, s36
    s_and_b32 s33, s37, 0xffff
    s_mov_b32 s34, 0
    s_mov_b32 s35, 0x00020000
    s_mov_b32 s18, 0
    s_mov_b32 s19, 0
    v_lshrrev_b32 v3, 2, v2
    v_lshlrev_b32 v3, 11, v3
    v_and_b32 v4, 3, v2
    v_lshl_add_u32 v0, v4, 4, v3
    s_and_b32 s53, s48, 1
    s_lshl_b32 s53, s53, 10
    s_and_b32 s54, s48, 2
    s_lshl_b32 s54, s54, 12
    s_add_u32 s53, s53, s54
    v_lshrrev_b32 v3, 2, v2
    v_lshlrev_b32 v5, 2, v4
    v_xor_b32 v3, v3, v5
    v_lshlrev_b32 v3, 4, v3
    v_and_b32 v5, 1, v2
    v_lshl_add_u32 v3, v5, 9, v3
    v_lshrrev_b32 v5, 1, v4
    v_lshl_add_u32 v3, v5, 12, v3
    v_add_u32 v1, s53, v3
    s_add_u32 s53, s60, 49152
    v_add_u32 v28, s53, v7
    v_add_u32 v29, 57344, v28
    v_bfe_u32 v3, v2, 3, 2
    v_lshl_add_u32 v11, v3, 2, v28
    v_add_u32 v12, 57344, v11
    v_readfirstlane_b32 s61, v8
    s_mov_b32 s62, 0x40000
SP_TL:
    s_cmp_lg_u32 s61, 0
    s_cbranch_scc1 SP_TOK
    s_sub_u32 s62, s62, 1
    s_cbranch_scc1 SP_TOK
    buffer_load_dword v8, v10, s[44:47], 0 offen sc1
    s_waitcnt vmcnt(0)
    v_readfirstlane_b32 s61, v8
    s_branch SP_TL
SP_TOK:
    s_barrier
    s_mov_b32 s62, 0x100000
L_SBW:
    ds_read_b32 v3, v15 offset:3072
    s_sub_u32 s62, s62, 1
    s_cbranch_scc1 L_SBX
    s_waitcnt lgkmcnt(0)
    v_cmp_eq_u32 vcc, 0, v3
    s_cbranch_vccnz L_SBW
L_SBX:
    s_add_u32 m0, s60, 77824
    s_add_u32 s53, s71, 475136
    buffer_load_dwordx4 v7, s[36:39], s53 offen sc1 lds
    s_add_u32 m0, s60, 81920
    s_add_u32 s53, s72, 475136
    buffer_load_dwordx4 v7, s[36:39], s53 offen sc1 lds
    s_add_u32 m0, s60, 86016
    s_add_u32 s53, s73, 475136
    buffer_load_dwordx4 v7, s[36:39], s53 offen sc1 lds
    s_add_u32 m0, s60, 90112
    s_add_u32 s53, s74, 475136
    buffer_load_dwordx4 v7, s[36:39], s53 offen sc1 lds
    s_add_u32 m0, s60, 94208
    s_add_u32 s53, s75, 475136
    buffer_load_dwordx4 v7, s[36:39], s53 offen sc1 lds
    s_add_u32 m0, s60, 98304
    s_add_u32 s53, s76, 475136
    buffer_load_dwordx4 v7, s[36:39], s53 offen sc1 lds
    s_add_u32 m0, s60, 102400
    s_add_u32 s53, s77, 475136
    buffer_load_dwordx4 v7, s[36:39], s53 offen sc1 lds
    s_waitcnt vmcnt(0)
    ds_read_b32 v64, v11 offset:28672
    ds_read_b32 v65, v11 offset:32768
    ds_read_b32 v66, v11 offset:36864
    ds_read_b32 v67, v11 offset:40960
    ds_read_b32 v68, v11 offset:45056
    ds_read_b32 v69, v11 offset:49152
    ds_read_b32 v70, v11 offset:53248
    s_waitcnt lgkmcnt(0)
    v_max3_u32 v3, v64, v65, v66
    v_max3_u32 v4, v67, v68, v69
    v_max3_u32 v3, v3, v4, v70
    v_cmp_eq_u32 vcc, -1, v3
    s_movk_i32 s62, 400
    s_cbranch_vccnz L_RS1
L_OKS1:
    buffer_load_dword v5, v10, s[44:47], 0 offen
    s_waitcnt vmcnt(5)
    s_branch L_P2H
L_SPM:
    ds_write_b32 v15, v10 offset:1024
    ds_write_b32 v15, v10 offset:3072
    v_lshrrev_b32 v3, 5, v2
    v_lshlrev_b32 v3, 12, v3
    v_bfe_u32 v4, v2, 2, 3
    v_lshl_add_u32 v3, v4, 7, v3
    v_and_b32 v5, 3, v2
    v_lshl_add_u32 v3, v5, 3, v3
    s_add_u32 s53, s60, 32768
    v_add_u32 v3, s53, v3
    v_lshrrev_b32 v4, 1, v4
    v_xor_b32 v5, 0, v4
    v_lshl_add_u32 v227, v5, 5, v3
    v_add_u32 v226, 0x10000, v227
    v_xor_b32 v5, 1, v4
    v_lshl_add_u32 v231, v5, 5, v3
    v_add_u32 v230, 0x10000, v231
    v_xor_b32 v5, 2, v4
    v_lshl_add_u32 v235, v5, 5, v3
    v_add_u32 v234, 0x10000, v235
    v_xor_b32 v5, 3, v4
    v_lshl_add_u32 v239, v5, 5, v3
    v_add_u32 v238, 0x10000, v239
    s_add_u32 m0, s60, 32768
    s_add_u32 s53, s64, 0
    buffer_load_dwordx4 v6, s[32:35], s53 offen lds
    s_add_u32 m0, s60, 36864
    s_add_u32 s53, s64, 16384
    buffer_load_dwordx4 v6, s[32:35], s53 offen lds
    s_add_u32 m0, s60, 147456
    s_add_u32 s53, s64, 32768
    buffer_load_dwordx4 v6, s[32:35], s53 offen lds
    s_add_u32 m0, s60, 151552
    s_add_u32 s53, s64, 49152
    buffer_load_dwordx4 v6, s[32:35], s53 offen lds
    s_add_u32 m0, s60, 155648
    s_add_u32 s53, s64, 65536
    buffer_load_dwordx4 v6, s[32:35], s53 offen lds
    s_add_u32 m0, s60, 159744
    s_add_u32 s53, s64, 81920
    buffer_load_dwordx4 v6, s[32:35], s53 offen lds
    s_add_u32 m0, s60, 49152
    s_add_u32 s53, s64, 98304
    buffer_load_dwordx4 v6, s[32:35], s53 offen lds
    s_add_u32 m0, s60, 53248
    s_add_u32 s53, s64, 114688
    buffer_load_dwordx4 v6, s[32:35], s53 offen lds
    s_add_u32 m0, s60, 57344
    s_add_u32 s53, s65, 0
    buffer_load_dwordx4 v6, s[32:35], s53 offen lds
    s_add_u32 m0, s60, 61440
    s_add_u32 s53, s65, 16384
    buffer_load_dwordx4 v6, s[32:35], s53 offen lds
    s_add_u32 m0, s60, 65536
    s_add_u32 s53, s65, 32768
    buffer_load_dwordx4 v6, s[32:35], s53 offen lds
    s_add_u32 m0, s60, 69632
    s_add_u32 s53, s65, 49152
    buffer_load_dwordx4 v6, s[32:35], s53 offen lds
    s_add_u32 m0, s60, 73728
    s_add_u32 s53, s65, 65536
    buffer_load_dwordx4 v6, s[32:35], s53 offen lds
    s_add_u32 m0, s60, 77824
    s_add_u32 s53, s65, 81920
    buffer_load_dwordx4 v6, s[32:35], s53 offen lds
    s_waitcnt vmcnt(12)
    ds_read_b64_tr_b16 v[16:17], v227 offset:0
    ds_read_b64_tr_b16 v[20:21], v231 offset:0
    ds_read_b64_tr_b16 v[24:25], v235 offset:0
    ds_read_b64_tr_b16 v[28:29], v239 offset:0
    s_waitcnt vmcnt(10)
    ds_read_b64_tr_b16 v[18:19], v226 offset:49152
    ds_read_b64_tr_b16 v[22:23], v230 offset:49152
    ds_read_b64_tr_b16 v[26:27], v234 offset:49152
    ds_read_b64_tr_b16 v[30:31], v238 offset:49152
    s_waitcnt lgkmcnt(4)
    s_add_u32 m0, s60, 32768
    s_add_u32 s53, s65, 98304
    buffer_load_dwordx4 v6, s[32:35], s53 offen lds
    s_add_u32 m0, s60, 36864
    s_add_u32 s53, s65, 114688
    buffer_load_dwordx4 v6, s[32:35], s53 offen lds
    s_add_u32 m0, s60, 81920
    s_add_u32 s53, s66, 0
    buffer_load_dwordx4 v6, s[32:35], s53 offen lds
    s_add_u32 m0, s60, 86016
    s_add_u32 s53, s66, 16384
    buffer_load_dwordx4 v6, s[32:35], s53 offen lds
    s_add_u32 m0, s60, 90112
    s_add_u32 s53, s66, 32768
    buffer_load_dwordx4 v6, s[32:35], s53 offen lds
    s_add_u32 m0, s60, 94208
    s_add_u32 s53, s66, 49152
    buffer_load_dwordx4 v6, s[32:35], s53 offen lds
    s_add_u32 m0, s60, 98304
    s_add_u32 s53, s66, 65536
    buffer_load_dwordx4 v6, s[32:35], s53 offen lds
    s_add_u32 m0, s60, 102400
    s_add_u32 s53, s66, 81920
    buffer_load_dwordx4 v6, s[32:35], s53 offen lds
    s_add_u32 m0, s60, 106496
    s_add_u32 s53, s66, 98304
    buffer_load_dwordx4 v6, s[32:35], s53 offen lds
    s_add_u32 m0, s60, 110592
    s_add_u32 s53, s66, 114688
    buffer_load_dwordx4 v6, s[32:35], s53 offen lds
    s_add_u32 m0, s60, 114688
    s_add_u32 s53, s67, 0
    buffer_load_dwordx4 v6, s[32:35], s53 offen lds
    s_add_u32 m0, s60, 118784
    s_add_u32 s53, s67, 16384
    buffer_load_dwordx4 v6, s[32:35], s53 offen lds
    s_add_u32 m0, s60, 122880
    s_add_u32 s53, s67, 32768
    buffer_load_dwordx4 v6, s[32:35], s53 offen lds
    s_add_u32 m0, s60, 126976
    s_add_u32 s53, s67, 49152
    buffer_load_dwordx4 v6, s[32:35], s53 offen lds
    s_waitcnt vmcnt(22)
    ds_read_b64_tr_b16 v[32:33], v226 offset:57344
    ds_read_b64_tr_b16 v[36:37], v230 offset:57344
    ds_read_b64_tr_b16 v[40:41], v234 offset:57344
    ds_read_b64_tr_b16 v[44:45], v238 offset:57344
    s_waitcnt lgkmcnt(4)
    s_add_u32 m0, s60, 147456
    s_add_u32 s53, s67, 65536
    buffer_load_dwordx4 v6, s[32:35], s53 offen lds
    s_add_u32 m0, s60, 151552
    s_add_u32 s53, s67, 81920
    buffer_load_dwordx4 v6, s[32:35], s53 offen lds
    s_waitcnt vmcnt(22)
    ds_read_b64_tr_b16 v[34:35], v227 offset:16384
    ds_read_b64_tr_b16 v[38:39], v231 offset:16384
    ds_read_b64_tr_b16 v[42:43], v235 offset:16384
    ds_read_b64_tr_b16 v[46:47], v239 offset:16384
    s_waitcnt lgkmcnt(4)
    s_add_u32 m0, s60, 155648
    s_add_u32 s53, s67, 98304
    buffer_load_dwordx4 v6, s[32:35], s53 offen lds
    s_add_u32 m0, s60, 159744
    s_add_u32 s53, s67, 114688
    buffer_load_dwordx4 v6, s[32:35], s53 offen lds
    s_waitcnt vmcnt(22)
    ds_read_b64_tr_b16 v[48:49], v227 offset:24576
    ds_read_b64_tr_b16 v[52:53], v231 offset:24576
    ds_read_b64_tr_b16 v[56:57], v235 offset:24576
    ds_read_b64_tr_b16 v[60:61], v239 offset:24576
    s_waitcnt lgkmcnt(4)
    s_add_u32 m0, s60, 49152
    s_add_u32 s53, s68, 0
    buffer_load_dwordx4 v6, s[32:35], s53 offen lds
    s_add_u32 m0, s60, 53248
    s_add_u32 s53, s68, 16384
    buffer_load_dwordx4 v6, s[32:35], s53 offen lds
    s_waitcnt vmcnt(22)
    ds_read_b64_tr_b16 v[50:51], v227 offset:32768
    ds_read_b64_tr_b16 v[54:55], v231 offset:32768
    ds_read_b64_tr_b16 v[58:59], v235 offset:32768
    ds_read_b64_tr_b16 v[62:63], v239 offset:32768
    s_waitcnt lgkmcnt(4)
    s_add_u32 m0, s60, 57344
    s_add_u32 s53, s68, 32768
    buffer_load_dwordx4 v6, s[32:35], s53 offen lds
    s_add_u32 m0, s60, 61440
    s_add_u32 s53, s68, 49152
    buffer_load_dwordx4 v6, s[32:35], s53 offen lds
    s_waitcnt vmcnt(22)
    ds_read_b64_tr_b16 v[64:65], v227 offset:40960
    ds_read_b64_tr_b16 v[68:69], v231 offset:40960
    ds_read_b64_tr_b16 v[72:73], v235 offset:40960
    ds_read_b64_tr_b16 v[76:77], v239 offset:40960
    s_waitcnt lgkmcnt(4)
    s_add_u32 m0, s60, 65536
    s_add_u32 s53, s68, 65536
    buffer_load_dwordx4 v6, s[32:35], s53 offen lds
    s_add_u32 m0, s60, 69632
    s_add_u32 s53, s68, 81920
    buffer_load_dwordx4 v6, s[32:35], s53 offen lds
    s_add_u32 m0, s60, 131072
    s_add_u32 s53, s68, 98304
    buffer_load_dwordx4 v6, s[32:35], s53 offen lds
    s_add_u32 m0, s60, 135168
    s_add_u32 s53, s68, 114688
    buffer_load_dwordx4 v6, s[32:35], s53 offen lds
    s_add_u32 m0, s60, 139264
    s_add_u32 s53, s69, 0
    buffer_load_dwordx4 v6, s[32:35], s53 offen lds
    s_add_u32 m0, s60, 143360
    s_add_u32 s53, s69, 16384
    buffer_load_dwordx4 v6, s[32:35], s53 offen lds
    s_waitcnt vmcnt(26)
    ds_read_b64_tr_b16 v[66:67], v227 offset:0
    ds_read_b64_tr_b16 v[70:71], v231 offset:0
    ds_read_b64_tr_b16 v[74:75], v235 offset:0
    ds_read_b64_tr_b16 v[78:79], v239 offset:0
    s_waitcnt vmcnt(24)
    ds_read_b64_tr_b16 v[80:81], v227 offset:49152
    ds_read_b64_tr_b16 v[84:85], v231 offset:49152
    ds_read_b64_tr_b16 v[88:89], v235 offset:49152
    ds_read_b64_tr_b16 v[92:93], v239 offset:49152
    s_waitcnt lgkmcnt(4)
    s_add_u32 m0, s60, 32768
    s_add_u32 s53, s69, 32768
    buffer_load_dwordx4 v6, s[32:35], s53 offen lds
    s_add_u32 m0, s60, 36864
    s_add_u32 s53, s69, 49152
    buffer_load_dwordx4 v6, s[32:35], s53 offen lds
    s_waitcnt vmcnt(24)
    ds_read_b64_tr_b16 v[82:83], v227 offset:57344
    ds_read_b64_tr_b16 v[86:87], v231 offset:57344
    ds_read_b64_tr_b16 v[90:91], v235 offset:57344
    ds_read_b64_tr_b16 v[94:95], v239 offset:57344
    s_waitcnt vmcnt(22)
    ds_read_b64_tr_b16 v[96:97], v226 offset:0
    ds_read_b64_tr_b16 v[100:101], v230 offset:0
    ds_read_b64_tr_b16 v[104:105], v234 offset:0
    ds_read_b64_tr_b16 v[108:109], v238 offset:0
    s_waitcnt vmcnt(20)
    ds_read_b64_tr_b16 v[98:99], v226 offset:8192
    ds_read_b64_tr_b16 v[102:103], v230 offset:8192
    ds_read_b64_tr_b16 v[106:107], v234 offset:8192
    ds_read_b64_tr_b16 v[110:111], v238 offset:8192
    s_waitcnt vmcnt(18)
    ds_read_b64_tr_b16 v[112:113], v226 offset:16384
    ds_read_b64_tr_b16 v[116:117], v230 offset:16384
    ds_read_b64_tr_b16 v[120:121], v234 offset:16384
    ds_read_b64_tr_b16 v[124:125], v238 offset:16384
    s_waitcnt lgkmcnt(4)
    s_add_u32 m0, s60, 106496
    s_add_u32 s53, s69, 65536
    buffer_load_dwordx4 v6, s[32:35], s53 offen lds
    s_add_u32 m0, s60, 110592
    s_add_u32 s53, s69, 81920
    buffer_load_dwordx4 v6, s[32:35], s53 offen lds
    s_waitcnt vmcnt(18)
    ds_read_b64_tr_b16 v[114:115], v226 offset:24576
    ds_read_b64_tr_b16 v[118:119], v230 offset:24576
    ds_read_b64_tr_b16 v[122:123], v234 offset:24576
    ds_read_b64_tr_b16 v[126:127], v238 offset:24576
    s_waitcnt lgkmcnt(4)
    s_add_u32 m0, s60, 114688
    s_add_u32 s53, s69, 98304
    buffer_load_dwordx4 v6, s[32:35], s53 offen lds
    s_add_u32 m0, s60, 118784
    s_add_u32 s53, s69, 114688
    buffer_load_dwordx4 v6, s[32:35], s53 offen lds
    s_waitcnt vmcnt(18)
    ds_read_b64_tr_b16 v[128:129], v226 offset:49152
    ds_read_b64_tr_b16 v[132:133], v230 offset:49152
    ds_read_b64_tr_b16 v[136:137], v234 offset:49152
    ds_read_b64_tr_b16 v[140:141], v238 offset:49152
    s_waitcnt lgkmcnt(4)
    s_add_u32 m0, s60, 122880
    s_add_u32 s53, s70, 0
    buffer_load_dwordx4 v6, s[32:35], s53 offen lds
    s_add_u32 m0, s60, 126976
    s_add_u32 s53, s70, 16384
    buffer_load_dwordx4 v6, s[32:35], s53 offen lds
    s_waitcnt vmcnt(18)
    ds_read_b64_tr_b16 v[130:131], v226 offset:57344
    ds_read_b64_tr_b16 v[134:135], v230 offset:57344
    ds_read_b64_tr_b16 v[138:139], v234 offset:57344
    ds_read_b64_tr_b16 v[142:143], v238 offset:57344
    s_waitcnt lgkmcnt(4)
    s_add_u32 m0, s60, 147456
    s_add_u32 s53, s70, 32768
    buffer_load_dwordx4 v6, s[32:35], s53 offen lds
    s_add_u32 m0, s60, 151552
    s_add_u32 s53, s70, 49152
    buffer_load_dwordx4 v6, s[32:35], s53 offen lds
    s_waitcnt vmcnt(18)
    ds_read_b64_tr_b16 v[144:145], v227 offset:16384
    ds_read_b64_tr_b16 v[148:149], v231 offset:16384
    ds_read_b64_tr_b16 v[152:153], v235 offset:16384
    ds_read_b64_tr_b16 v[156:157], v239 offset:16384
    s_waitcnt lgkmcnt(4)
    s_add_u32 m0, s60, 155648
    s_add_u32 s53, s70, 65536
    buffer_load_dwordx4 v6, s[32:35], s53 offen lds
    s_add_u32 m0, s60, 159744
    s_add_u32 s53, s70, 81920
    buffer_load_dwordx4 v6, s[32:35], s53 offen lds
    s_waitcnt vmcnt(18)
    ds_read_b64_tr_b16 v[146:147], v227 offset:24576
    ds_read_b64_tr_b16 v[150:151], v231 offset:24576
    ds_read_b64_tr_b16 v[154:155], v235 offset:24576
    ds_read_b64_tr_b16 v[158:159], v239 offset:24576
    s_waitcnt vmcnt(16)
    ds_read_b64_tr_b16 v[160:161], v227 offset:32768
    ds_read_b64_tr_b16 v[164:165], v231 offset:32768
    ds_read_b64_tr_b16 v[168:169], v235 offset:32768
    ds_read_b64_tr_b16 v[172:173], v239 offset:32768
    v_mul_u32_u24 v5, 4096, v2
    s_waitcnt vmcnt(0)
    s_add_u32 s53, s60, 49152
    v_bfe_u32 v3, v2, 3, 2
    v_lshl_add_u32 v3, v3, 2, v7
    v_add_u32 v11, s53, v3
    v_xor_b32 v14, 256, v15
    s_and_b32 s53, s60, 2048
    s_add_u32 s53, s53, 49152
    v_add_u32 v0, s53, v7
    v_add_u32 v1, 57344, v0
    v_lshrrev_b32 v3, 5, v2
    v_lshlrev_b32 v3, 6, v3
    v_xor_b32 v3, v3, v7
    v_add_u32 v2, s60, v3
    v_readfirstlane_b32 s61, v8
    s_mov_b32 s62, 0x40000
SQ_TL:
    s_cmp_lg_u32 s61, 0
    s_cbranch_scc1 SQ_TOK
    s_sub_u32 s62, s62, 1
    s_cbranch_scc1 SQ_TOK
    buffer_load_dword v8, v10, s[44:47], 0 offen sc1
    s_waitcnt vmcnt(0)
    v_readfirstlane_b32 s61, v8
    s_branch SQ_TL
SQ_TOK:
    s_mov_b32 s62, 0x20000
    s_mov_b64 exec, 0x3fff
L_POLLSZ:
    buffer_load_dword v3, v9, s[36:39], 0 offen offset:128 sc1
    s_waitcnt vmcnt(0)
L_PCSZ:
    v_cmp_ne_u32 vcc, s61, v3
    s_cbranch_vccz L_GOSZ
    s_sub_u32 s62, s62, 1
    s_cbranch_scc1 L_GOSZ
    s_sleep 4
    s_branch L_POLLSZ
L_GOSZ:
    s_mov_b64 exec, -1
    s_mov_b32 s62, 0x8000
    s_mov_b64 exec, 0x7f
L_PRE:
    buffer_load_dword v3, v5, s[36:39], s3 offen sc1
    s_waitcnt vmcnt(0)
    v_cmp_ne_u32 vcc, -1, v3
    s_cbranch_vccnz L_PREX
    s_sleep 4
    s_sub_u32 s62, s62, 1
    s_cbranch_scc0 L_PRE
L_PREX:
    s_mov_b64 exec, -1
    s_waitcnt lgkmcnt(0)
    s_barrier
    s_branch L_P2M
    .fill 182, 4, 0xbf810000
L_PAD_p2m:
    s_branch L_DISP
L_P2M:
    s_add_u32 m0, s60, 49152
    s_add_u32 s53, s71, 0
    buffer_load_dwordx4 v7, s[36:39], s53 offen sc1 lds
    s_add_u32 m0, s60, 53248
    s_add_u32 s53, s72, 0
    buffer_load_dwordx4 v7, s[36:39], s53 offen sc1 lds
    s_add_u32 m0, s60, 57344
    s_add_u32 s53, s73, 0
    buffer_load_dwordx4 v7, s[36:39], s53 offen sc1 lds
    s_add_u32 m0, s60, 61440
    s_add_u32 s53, s74, 0
    buffer_load_dwordx4 v7, s[36:39], s53 offen sc1 lds
    ds_write_b32 v15, v15 offset:3072
    s_add_u32 m0, s60, 65536
    s_add_u32 s53, s75, 0
    buffer_load_dwordx4 v7, s[36:39], s53 offen sc1 lds
    s_add_u32 m0, s60, 69632
    s_add_u32 s53, s76, 0
    buffer_load_dwordx4 v7, s[36:39], s53 offen sc1 lds
    s_add_u32 m0, s60, 73728
    s_add_u32 s53, s77, 0
    buffer_load_dwordx4 v7, s[36:39], s53 offen sc1 lds
    s_waitcnt vmcnt(21)
    ds_read_b64_tr_b16 v[162:163], v226 offset:32768
    ds_read_b64_tr_b16 v[166:167], v230 offset:32768
    ds_read_b64_tr_b16 v[170:171], v234 offset:32768
    ds_read_b64_tr_b16 v[174:175], v238 offset:32768
    s_waitcnt vmcnt(19)
    ds_read_b64_tr_b16 v[176:177], v226 offset:40960
    ds_read_b64_tr_b16 v[180:181], v230 offset:40960
    ds_read_b64_tr_b16 v[184:185], v234 offset:40960
    ds_read_b64_tr_b16 v[188:189], v238 offset:40960
    s_waitcnt vmcnt(17)
    ds_read_b64_tr_b16 v[178:179], v227 offset:0
    ds_read_b64_tr_b16 v[182:183], v231 offset:0
    ds_read_b64_tr_b16 v[186:187], v235 offset:0
    ds_read_b64_tr_b16 v[190:191], v239 offset:0
    s_waitcnt lgkmcnt(4)
    s_add_u32 m0, s60, 139264
    s_add_u32 s53, s70, 98304
    buffer_load_dwordx4 v6, s[32:35], s53 offen lds
    s_add_u32 m0, s60, 143360
    s_add_u32 s53, s70, 114688
    buffer_load_dwordx4 v6, s[32:35], s53 offen lds
    s_waitcnt vmcnt(17)
    ds_read_b64_tr_b16 v[192:193], v226 offset:8192
    ds_read_b64_tr_b16 v[196:197], v230 offset:8192
    ds_read_b64_tr_b16 v[200:201], v234 offset:8192
    ds_read_b64_tr_b16 v[204:205], v238 offset:8192
    s_waitcnt vmcnt(15)
    ds_read_b64_tr_b16 v[194:195], v226 offset:16384
    ds_read_b64_tr_b16 v[198:199], v230 offset:16384
    ds_read_b64_tr_b16 v[202:203], v234 offset:16384
    ds_read_b64_tr_b16 v[206:207], v238 offset:16384
    s_waitcnt vmcnt(13)
    ds_read_b64_tr_b16 v[208:209], v226 offset:24576
    ds_read_b64_tr_b16 v[212:213], v230 offset:24576
    ds_read_b64_tr_b16 v[216:217], v234 offset:24576
    ds_read_b64_tr_b16 v[220:221], v238 offset:24576
    s_setprio 3
    s_waitcnt vmcnt(2)
    ds_read_b32 v240, v11 offset:0
    ds_read_b32 v241, v11 offset:4096
    ds_read_b32 v242, v11 offset:8192
    ds_read_b32 v243, v11 offset:12288
    ds_read_b32 v244, v11 offset:16384
    ds_read_b32 v245, v11 offset:20480
    ds_read_b32 v246, v11 offset:24576
    s_waitcnt lgkmcnt(0)
    v_max3_u32 v3, v240, v241, v242
    v_max3_u32 v4, v243, v244, v245
    v_max3_u32 v3, v3, v4, v246
    v_cmp_eq_u32 vcc, -1, v3
    s_movk_i32 s62, 400
    s_cbranch_vccnz L_RM0
L_OKM0:
    ds_write_b32 v15, v15 offset:1024
    s_mov_b32 s62, 0x400000
L_PAIR:
    ds_read_b32 v3, v14 offset:1024
    s_sub_u32 s62, s62, 1
    s_cbranch_scc1 L_PAIRX
    s_waitcnt lgkmcnt(0)
    v_cmp_ne_u32 vcc, 0, v3
    s_cbranch_vccz L_PAIR
L_PAIRX:
    v_xor_b32 v3, 128, v2
    ds_read_b128 v[4:7], v0 offset:0
    ds_read_b128 v[8:11], v0 offset:1024
L_ST0:
    s_waitcnt lgkmcnt(1)
    v_mfma_f32_16x16x32_bf16 v[240:243], v[16:19], v[4:7], 0
    ds_read_b128 v[12:15], v0 offset:4096
    v_mfma_f32_16x16x32_bf16 v[244:247], v[20:23], v[4:7], 0
    v_mfma_f32_16x16x32_bf16 v[248:251], v[24:27], v[4:7], 0
    v_mfma_f32_16x16x32_bf16 v[252:255], v[28:31], v[4:7], 0
L_ST1:
    s_waitcnt lgkmcnt(1)
    v_mfma_f32_16x16x32_bf16 v[240:243], v[32:35], v[8:11], v[240:243]
    ds_read_b128 v[4:7], v0 offset:5120
    v_mfma_f32_16x16x32_bf16 v[244:247], v[36:39], v[8:11], v[244:247]
    v_mfma_f32_16x16x32_bf16 v[248:251], v[40:43], v[8:11], v[248:251]
    v_mfma_f32_16x16x32_bf16 v[252:255], v[44:47], v[8:11], v[252:255]
L_ST2:
    s_waitcnt lgkmcnt(1)
    v_mfma_f32_16x16x32_bf16 v[240:243], v[48:51], v[12:15], v[240:243]
    ds_read_b128 v[8:11], v0 offset:8192
    v_mfma_f32_16x16x32_bf16 v[244:247], v[52:55], v[12:15], v[244:247]
    v_mfma_f32_16x16x32_bf16 v[248:251], v[56:59], v[12:15], v[248:251]
    v_mfma_f32_16x16x32_bf16 v[252:255], v[60:63], v[12:15], v[252:255]
L_ST3:
    s_waitcnt lgkmcnt(1)
    v_mfma_f32_16x16x32_bf16 v[240:243], v[64:67], v[4:7], v[240:243]
    ds_read_b128 v[12:15], v0 offset:9216
    v_mfma_f32_16x16x32_bf16 v[244:247], v[68:71], v[4:7], v[244:247]
    v_mfma_f32_16x16x32_bf16 v[248:251], v[72:75], v[4:7], v[248:251]
    v_mfma_f32_16x16x32_bf16 v[252:255], v[76:79], v[4:7], v[252:255]
L_ST4:
    s_waitcnt lgkmcnt(1)
    v_mfma_f32_16x16x32_bf16 v[240:243], v[80:83], v[8:11], v[240:243]
    ds_read_b128 v[4:7], v0 offset:12288
    v_mfma_f32_16x16x32_bf16 v[244:247], v[84:87], v[8:11], v[244:247]
    v_mfma_f32_16x16x32_bf16 v[248:251], v[88:91], v[8:11], v[248:251]
    v_mfma_f32_16x16x32_bf16 v[252:255], v[92:95], v[8:11], v[252:255]
L_ST5:
    s_waitcnt lgkmcnt(1)
    v_mfma_f32_16x16x32_bf16 v[240:243], v[96:99], v[12:15], v[240:243]
    ds_read_b128 v[8:11], v0 offset:13312
    v_mfma_f32_16x16x32_bf16 v[244:247], v[100:103], v[12:15], v[244:247]
    v_mfma_f32_16x16x32_bf16 v[248:251], v[104:107], v[12:15], v[248:251]
    v_mfma_f32_16x16x32_bf16 v[252:255], v[108:111], v[12:15], v[252:255]
L_ST6:
    s_waitcnt lgkmcnt(1)
    v_mfma_f32_16x16x32_bf16 v[240:243], v[112:115], v[4:7], v[240:243]
    ds_read_b128 v[12:15], v0 offset:16384
    v_mfma_f32_16x16x32_bf16 v[244:247], v[116:119], v[4:7], v[244:247]
    v_mfma_f32_16x16x32_bf16 v[248:251], v[120:123], v[4:7], v[248:251]
    v_mfma_f32_16x16x32_bf16 v[252:255], v[124:127], v[4:7], v[252:255]
L_ST7:
    s_waitcnt lgkmcnt(1)
    v_mfma_f32_16x16x32_bf16 v[240:243], v[128:131], v[8:11], v[240:243]
    ds_read_b128 v[4:7], v0 offset:17408
    v_mfma_f32_16x16x32_bf16 v[244:247], v[132:135], v[8:11], v[244:247]
    v_mfma_f32_16x16x32_bf16 v[248:251], v[136:139], v[8:11], v[248:251]
    ds_read_b64_tr_b16 v[210:211], v226 offset:49152
    ds_read_b64_tr_b16 v[214:215], v230 offset:49152
    ds_read_b64_tr_b16 v[218:219], v234 offset:49152
    ds_read_b64_tr_b16 v[222:223], v238 offset:49152
    v_mfma_f32_16x16x32_bf16 v[252:255], v[140:143], v[8:11], v[252:255]
L_ST8:
    s_waitcnt lgkmcnt(5)
    v_mfma_f32_16x16x32_bf16 v[240:243], v[144:147], v[12:15], v[240:243]
    ds_read_b128 v[8:11], v0 offset:20480
    v_mfma_f32_16x16x32_bf16 v[244:247], v[148:151], v[12:15], v[244:247]
    v_mfma_f32_16x16x32_bf16 v[248:251], v[152:155], v[12:15], v[248:251]
    ds_read_b64_tr_b16 v[224:225], v226 offset:57344
    ds_read_b64_tr_b16 v[228:229], v230 offset:57344
    ds_read_b64_tr_b16 v[232:233], v234 offset:57344
    ds_read_b64_tr_b16 v[236:237], v238 offset:57344
    v_mfma_f32_16x16x32_bf16 v[252:255], v[156:159], v[12:15], v[252:255]
L_ST9:
    s_waitcnt lgkmcnt(9)
    v_mfma_f32_16x16x32_bf16 v[240:243], v[160:163], v[4:7], v[240:243]
    ds_read_b128 v[12:15], v0 offset:21504
    v_mfma_f32_16x16x32_bf16 v[244:247], v[164:167], v[4:7], v[244:247]
    v_mfma_f32_16x16x32_bf16 v[248:251], v[168:171], v[4:7], v[248:251]
    s_waitcnt vmcnt(0)
    ds_read_b64_tr_b16 v[226:227], v226 offset:40960
    ds_read_b64_tr_b16 v[230:231], v230 offset:40960
    ds_read_b64_tr_b16 v[234:235], v234 offset:40960
    ds_read_b64_tr_b16 v[238:239], v238 offset:40960
    v_mfma_f32_16x16x32_bf16 v[252:255], v[172:175], v[4:7], v[252:255]
L_ST10:
    s_waitcnt lgkmcnt(9)
    v_mfma_f32_16x16x32_bf16 v[240:243], v[176:179], v[8:11], v[240:243]
    ds_read_b128 v[4:7], v0 offset:24576
    v_mfma_f32_16x16x32_bf16 v[244:247], v[180:183], v[8:11], v[244:247]
    v_mfma_f32_16x16x32_bf16 v[248:251], v[184:187], v[8:11], v[248:251]
    v_mfma_f32_16x16x32_bf16 v[252:255], v[188:191], v[8:11], v[252:255]
L_ST11:
    s_waitcnt lgkmcnt(5)
    v_mfma_f32_16x16x32_bf16 v[240:243], v[192:195], v[12:15], v[240:243]
    ds_read_b128 v[8:11], v0 offset:25600
    v_mfma_f32_16x16x32_bf16 v[244:247], v[196:199], v[12:15], v[244:247]
    v_mfma_f32_16x16x32_bf16 v[248:251], v[200:203], v[12:15], v[248:251]
    v_mfma_f32_16x16x32_bf16 v[252:255], v[204:207], v[12:15], v[252:255]
L_ST12:
    s_waitcnt lgkmcnt(1)
    v_mfma_f32_16x16x32_bf16 v[240:243], v[208:211], v[4:7], v[240:243]
    s_barrier
    ds_read_b128 v[12:15], v0 offset:28672
    v_mfma_f32_16x16x32_bf16 v[244:247], v[212:215], v[4:7], v[244:247]
    v_mfma_f32_16x16x32_bf16 v[248:251], v[216:219], v[4:7], v[248:251]
    v_mfma_f32_16x16x32_bf16 v[252:255], v[220:223], v[4:7], v[252:255]
L_ST13:
    s_waitcnt lgkmcnt(1)
    v_mfma_f32_16x16x32_bf16 v[240:243], v[224:227], v[8:11], v[240:243]
    ds_read_b128 v[4:7], v0 offset:29696
    v_mfma_f32_16x16x32_bf16 v[244:247], v[228:231], v[8:11], v[244:247]
    v_mfma_f32_16x16x32_bf16 v[248:251], v[232:235], v[8:11], v[248:251]
    v_mfma_f32_16x16x32_bf16 v[252:255], v[236:239], v[8:11], v[252:255]
L_ST14:
    s_waitcnt lgkmcnt(1)
    ds_write_b128 v2, v[240:243] offset:0
    v_mfma_f32_16x16x32_bf16 v[240:243], v[16:19], v[12:15], 0
    ds_read_b128 v[8:11], v0 offset:32768
    ds_write_b128 v3, v[244:247] offset:4096
    v_mfma_f32_16x16x32_bf16 v[244:247], v[20:23], v[12:15], 0
    ds_write_b128 v2, v[248:251] offset:8192
    v_mfma_f32_16x16x32_bf16 v[248:251], v[24:27], v[12:15], 0
    ds_write_b128 v3, v[252:255] offset:12288
    v_mfma_f32_16x16x32_bf16 v[252:255], v[28:31], v[12:15], 0
L_ST15:
    s_waitcnt lgkmcnt(5)
    v_mfma_f32_16x16x32_bf16 v[240:243], v[32:35], v[4:7], v[240:243]
    ds_read_b128 v[12:15], v0 offset:33792
    v_mfma_f32_16x16x32_bf16 v[244:247], v[36:39], v[4:7], v[244:247]
    v_xor_b32 v2, 0x4000, v2
    v_mfma_f32_16x16x32_bf16 v[248:251], v[40:43], v[4:7], v[248:251]
    v_xor_b32 v3, 0x4000, v3
    v_mfma_f32_16x16x32_bf16 v[252:255], v[44:47], v[4:7], v[252:255]
L_ST16:
    s_waitcnt lgkmcnt(4)
    v_mfma_f32_16x16x32_bf16 v[240:243], v[48:51], v[8:11], v[240:243]
    ds_read_b128 v[4:7], v0 offset:36864
    v_mfma_f32_16x16x32_bf16 v[244:247], v[52:55], v[8:11], v[244:247]
    v_mfma_f32_16x16x32_bf16 v[248:251], v[56:59], v[8:11], v[248:251]
    v_mfma_f32_16x16x32_bf16 v[252:255], v[60:63], v[8:11], v[252:255]
L_ST17:
    s_waitcnt lgkmcnt(1)
    v_mfma_f32_16x16x32_bf16 v[240:243], v[64:67], v[12:15], v[240:243]
    ds_read_b128 v[8:11], v0 offset:37888
    v_mfma_f32_16x16x32_bf16 v[244:247], v[68:71], v[12:15], v[244:247]
    v_mfma_f32_16x16x32_bf16 v[248:251], v[72:75], v[12:15], v[248:251]
    v_mfma_f32_16x16x32_bf16 v[252:255], v[76:79], v[12:15], v[252:255]
L_ST18:
    s_waitcnt lgkmcnt(1)
    v_mfma_f32_16x16x32_bf16 v[240:243], v[80:83], v[4:7], v[240:243]
    ds_read_b128 v[12:15], v0 offset:40960
    v_mfma_f32_16x16x32_bf16 v[244:247], v[84:87], v[4:7], v[244:247]
    v_mfma_f32_16x16x32_bf16 v[248:251], v[88:91], v[4:7], v[248:251]
    v_mfma_f32_16x16x32_bf16 v[252:255], v[92:95], v[4:7], v[252:255]
L_ST19:
    s_waitcnt lgkmcnt(1)
    v_mfma_f32_16x16x32_bf16 v[240:243], v[96:99], v[8:11], v[240:243]
    ds_read_b128 v[4:7], v0 offset:41984
    v_mfma_f32_16x16x32_bf16 v[244:247], v[100:103], v[8:11], v[244:247]
    v_mfma_f32_16x16x32_bf16 v[248:251], v[104:107], v[8:11], v[248:251]
    v_mfma_f32_16x16x32_bf16 v[252:255], v[108:111], v[8:11], v[252:255]
L_ST20:
    s_waitcnt lgkmcnt(1)
    v_mfma_f32_16x16x32_bf16 v[240:243], v[112:115], v[12:15], v[240:243]
    ds_read_b128 v[8:11], v0 offset:45056
    v_mfma_f32_16x16x32_bf16 v[244:247], v[116:119], v[12:15], v[244:247]
    v_mfma_f32_16x16x32_bf16 v[248:251], v[120:123], v[12:15], v[248:251]
    v_mfma_f32_16x16x32_bf16 v[252:255], v[124:127], v[12:15], v[252:255]
L_ST21:
    s_waitcnt lgkmcnt(1)
    v_mfma_f32_16x16x32_bf16 v[240:243], v[128:131], v[4:7], v[240:243]
    ds_read_b128 v[12:15], v0 offset:46080
    v_mfma_f32_16x16x32_bf16 v[244:247], v[132:135], v[4:7], v[244:247]
    v_mfma_f32_16x16x32_bf16 v[248:251], v[136:139], v[4:7], v[248:251]
    v_mfma_f32_16x16x32_bf16 v[252:255], v[140:143], v[4:7], v[252:255]
L_ST22:
    s_waitcnt lgkmcnt(1)
    v_mfma_f32_16x16x32_bf16 v[240:243], v[144:147], v[8:11], v[240:243]
    ds_read_b128 v[4:7], v0 offset:49152
    v_mfma_f32_16x16x32_bf16 v[244:247], v[148:151], v[8:11], v[244:247]
    v_mfma_f32_16x16x32_bf16 v[248:251], v[152:155], v[8:11], v[248:251]
    v_mfma_f32_16x16x32_bf16 v[252:255], v[156:159], v[8:11], v[252:255]
L_ST23:
    s_waitcnt lgkmcnt(1)
    v_mfma_f32_16x16x32_bf16 v[240:243], v[160:163], v[12:15], v[240:243]
    ds_read_b128 v[8:11], v0 offset:50176
    v_mfma_f32_16x16x32_bf16 v[244:247], v[164:167], v[12:15], v[244:247]
    v_mfma_f32_16x16x32_bf16 v[248:251], v[168:171], v[12:15], v[248:251]
    v_mfma_f32_16x16x32_bf16 v[252:255], v[172:175], v[12:15], v[252:255]
L_ST24:
    s_waitcnt lgkmcnt(1)
    v_mfma_f32_16x16x32_bf16 v[240:243], v[176:179], v[4:7], v[240:243]
    ds_read_b128 v[12:15], v0 offset:53248
    v_mfma_f32_16x16x32_bf16 v[244:247], v[180:183], v[4:7], v[244:247]
    v_mfma_f32_16x16x32_bf16 v[248:251], v[184:187], v[4:7], v[248:251]
    v_mfma_f32_16x16x32_bf16 v[252:255], v[188:191], v[4:7], v[252:255]
L_ST25:
    s_waitcnt lgkmcnt(1)
    v_mfma_f32_16x16x32_bf16 v[240:243], v[192:195], v[8:11], v[240:243]
    s_barrier
    ds_read_b128 v[4:7], v0 offset:54272
    v_mfma_f32_16x16x32_bf16 v[244:247], v[196:199], v[8:11], v[244:247]
    v_mfma_f32_16x16x32_bf16 v[248:251], v[200:203], v[8:11], v[248:251]
    v_mfma_f32_16x16x32_bf16 v[252:255], v[204:207], v[8:11], v[252:255]
L_ST26:
    s_waitcnt lgkmcnt(1)
    v_mfma_f32_16x16x32_bf16 v[240:243], v[208:211], v[12:15], v[240:243]
    ds_read_b128 v[8:11], v1 offset:0
    v_mfma_f32_16x16x32_bf16 v[244:247], v[212:215], v[12:15], v[244:247]
    v_mfma_f32_16x16x32_bf16 v[248:251], v[216:219], v[12:15], v[248:251]
    v_mfma_f32_16x16x32_bf16 v[252:255], v[220:223], v[12:15], v[252:255]
L_ST27:
    s_waitcnt lgkmcnt(1)
    v_mfma_f32_16x16x32_bf16 v[240:243], v[224:227], v[4:7], v[240:243]
    ds_read_b128 v[12:15], v1 offset:1024
    v_mfma_f32_16x16x32_bf16 v[244:247], v[228:231], v[4:7], v[244:247]
    v_mfma_f32_16x16x32_bf16 v[248:251], v[232:235], v[4:7], v[248:251]
    v_mfma_f32_16x16x32_bf16 v[252:255], v[236:239], v[4:7], v[252:255]
    s_cmp_lg_u32 s0, s0
L_ST28:
L_PAD_p2m.4:
    s_cbranch_execz L_DISP
    s_waitcnt lgkmcnt(1)
    ds_write_b128 v2, v[240:243] offset:0
    v_mfma_f32_16x16x32_bf16 v[240:243], v[16:19], v[8:11], 0
    ds_read_b128 v[4:7], v1 offset:4096
    ds_write_b128 v3, v[244:247] offset:4096
    v_mfma_f32_16x16x32_bf16 v[244:247], v[20:23], v[8:11], 0
    ds_write_b128 v2, v[248:251] offset:8192
    v_mfma_f32_16x16x32_bf16 v[248:251], v[24:27], v[8:11], 0
    ds_write_b128 v3, v[252:255] offset:12288
    v_mfma_f32_16x16x32_bf16 v[252:255], v[28:31], v[8:11], 0
L_ST29:
    s_waitcnt lgkmcnt(5)
    v_mfma_f32_16x16x32_bf16 v[240:243], v[32:35], v[12:15], v[240:243]
    ds_read_b128 v[8:11], v1 offset:5120
    v_mfma_f32_16x16x32_bf16 v[244:247], v[36:39], v[12:15], v[244:247]
    v_xor_b32 v2, 0x4000, v2
    v_mfma_f32_16x16x32_bf16 v[248:251], v[40:43], v[12:15], v[248:251]
    v_xor_b32 v3, 0x4000, v3
    v_mfma_f32_16x16x32_bf16 v[252:255], v[44:47], v[12:15], v[252:255]
L_ST30:
    s_waitcnt lgkmcnt(1)
    v_mfma_f32_16x16x32_bf16 v[240:243], v[48:51], v[4:7], v[240:243]
    s_cbranch_scc0 L_NB5
    s_barrier
L_NB5:
    ds_read_b128 v[12:15], v1 offset:8192
    v_mfma_f32_16x16x32_bf16 v[244:247], v[52:55], v[4:7], v[244:247]
    v_mfma_f32_16x16x32_bf16 v[248:251], v[56:59], v[4:7], v[248:251]
    v_mfma_f32_16x16x32_bf16 v[252:255], v[60:63], v[4:7], v[252:255]
L_ST31:
    s_waitcnt lgkmcnt(1)
    v_mfma_f32_16x16x32_bf16 v[240:243], v[64:67], v[8:11], v[240:243]
    ds_read_b128 v[4:7], v1 offset:9216
    v_mfma_f32_16x16x32_bf16 v[244:247], v[68:71], v[8:11], v[244:247]
    v_mfma_f32_16x16x32_bf16 v[248:251], v[72:75], v[8:11], v[248:251]
    v_mfma_f32_16x16x32_bf16 v[252:255], v[76:79], v[8:11], v[252:255]
L_ST32:
    s_waitcnt lgkmcnt(1)
    v_mfma_f32_16x16x32_bf16 v[240:243], v[80:83], v[12:15], v[240:243]
    ds_read_b128 v[8:11], v1 offset:12288
    v_mfma_f32_16x16x32_bf16 v[244:247], v[84:87], v[12:15], v[244:247]
    v_mfma_f32_16x16x32_bf16 v[248:251], v[88:91], v[12:15], v[248:251]
    v_mfma_f32_16x16x32_bf16 v[252:255], v[92:95], v[12:15], v[252:255]
L_ST33:
    s_waitcnt lgkmcnt(1)
    v_mfma_f32_16x16x32_bf16 v[240:243], v[96:99], v[4:7], v[240:243]
    ds_read_b128 v[12:15], v1 offset:13312
    v_mfma_f32_16x16x32_bf16 v[244:247], v[100:103], v[4:7], v[244:247]
    v_mfma_f32_16x16x32_bf16 v[248:251], v[104:107], v[4:7], v[248:251]
    v_mfma_f32_16x16x32_bf16 v[252:255], v[108:111], v[4:7], v[252:255]
L_ST34:
    s_waitcnt lgkmcnt(1)
    v_mfma_f32_16x16x32_bf16 v[240:243], v[112:115], v[8:11], v[240:243]
    ds_read_b128 v[4:7], v1 offset:16384
    v_mfma_f32_16x16x32_bf16 v[244:247], v[116:119], v[8:11], v[244:247]
    v_mfma_f32_16x16x32_bf16 v[248:251], v[120:123], v[8:11], v[248:251]
    v_mfma_f32_16x16x32_bf16 v[252:255], v[124:127], v[8:11], v[252:255]
L_ST35:
    s_waitcnt lgkmcnt(1)
    v_mfma_f32_16x16x32_bf16 v[240:243], v[128:131], v[12:15], v[240:243]
    ds_read_b128 v[8:11], v1 offset:17408
    v_mfma_f32_16x16x32_bf16 v[244:247], v[132:135], v[12:15], v[244:247]
    v_mfma_f32_16x16x32_bf16 v[248:251], v[136:139], v[12:15], v[248:251]
    v_mfma_f32_16x16x32_bf16 v[252:255], v[140:143], v[12:15], v[252:255]
L_ST36:
    s_waitcnt lgkmcnt(1)
    v_mfma_f32_16x16x32_bf16 v[240:243], v[144:147], v[4:7], v[240:243]
    ds_read_b128 v[12:15], v1 offset:20480
    v_mfma_f32_16x16x32_bf16 v[244:247], v[148:151], v[4:7], v[244:247]
    v_mfma_f32_16x16x32_bf16 v[248:251], v[152:155], v[4:7], v[248:251]
    v_mfma_f32_16x16x32_bf16 v[252:255], v[156:159], v[4:7], v[252:255]
L_ST37:
    s_waitcnt lgkmcnt(1)
    v_mfma_f32_16x16x32_bf16 v[240:243], v[160:163], v[8:11], v[240:243]
    ds_read_b128 v[4:7], v1 offset:21504
    v_mfma_f32_16x16x32_bf16 v[244:247], v[164:167], v[8:11], v[244:247]
    v_mfma_f32_16x16x32_bf16 v[248:251], v[168:171], v[8:11], v[248:251]
    v_mfma_f32_16x16x32_bf16 v[252:255], v[172:175], v[8:11], v[252:255]
L_ST38:
    s_waitcnt lgkmcnt(1)
    v_mfma_f32_16x16x32_bf16 v[240:243], v[176:179], v[12:15], v[240:243]
    ds_read_b128 v[8:11], v1 offset:24576
    v_mfma_f32_16x16x32_bf16 v[244:247], v[180:183], v[12:15], v[244:247]
    v_mfma_f32_16x16x32_bf16 v[248:251], v[184:187], v[12:15], v[248:251]
    v_mfma_f32_16x16x32_bf16 v[252:255], v[188:191], v[12:15], v[252:255]
L_ST39:
    s_waitcnt lgkmcnt(1)
    v_mfma_f32_16x16x32_bf16 v[240:243], v[192:195], v[4:7], v[240:243]
    s_cbranch_scc1 L_NB2
    s_barrier
L_NB2:
    ds_read_b128 v[12:15], v1 offset:25600
    v_mfma_f32_16x16x32_bf16 v[244:247], v[196:199], v[4:7], v[244:247]
    v_mfma_f32_16x16x32_bf16 v[248:251], v[200:203], v[4:7], v[248:251]
    v_mfma_f32_16x16x32_bf16 v[252:255], v[204:207], v[4:7], v[252:255]
L_ST40:
    s_waitcnt lgkmcnt(1)
    v_mfma_f32_16x16x32_bf16 v[240:243], v[208:211], v[8:11], v[240:243]
    ds_read_b128 v[4:7], v1 offset:28672
    v_mfma_f32_16x16x32_bf16 v[244:247], v[212:215], v[8:11], v[244:247]
    v_mfma_f32_16x16x32_bf16 v[248:251], v[216:219], v[8:11], v[248:251]
    v_mfma_f32_16x16x32_bf16 v[252:255], v[220:223], v[8:11], v[252:255]
L_ST41:
    s_waitcnt lgkmcnt(1)
    v_mfma_f32_16x16x32_bf16 v[240:243], v[224:227], v[12:15], v[240:243]
    ds_read_b128 v[8:11], v1 offset:29696
    v_mfma_f32_16x16x32_bf16 v[244:247], v[228:231], v[12:15], v[244:247]
    v_mfma_f32_16x16x32_bf16 v[248:251], v[232:235], v[12:15], v[248:251]
    v_mfma_f32_16x16x32_bf16 v[252:255], v[236:239], v[12:15], v[252:255]
L_ST42:
    s_waitcnt lgkmcnt(1)
    ds_write_b128 v2, v[240:243] offset:0
    v_mfma_f32_16x16x32_bf16 v[240:243], v[16:19], v[4:7], 0
    ds_read_b128 v[12:15], v1 offset:32768
    ds_write_b128 v3, v[244:247] offset:4096
    v_mfma_f32_16x16x32_bf16 v[244:247], v[20:23], v[4:7], 0
    ds_write_b128 v2, v[248:251] offset:8192
    v_mfma_f32_16x16x32_bf16 v[248:251], v[24:27], v[4:7], 0
    ds_write_b128 v3, v[252:255] offset:12288
    v_mfma_f32_16x16x32_bf16 v[252:255], v[28:31], v[4:7], 0
L_ST43:
    s_waitcnt lgkmcnt(5)
    v_mfma_f32_16x16x32_bf16 v[240:243], v[32:35], v[8:11], v[240:243]
    ds_read_b128 v[4:7], v1 offset:33792
    v_mfma_f32_16x16x32_bf16 v[244:247], v[36:39], v[8:11], v[244:247]
    v_xor_b32 v2, 0x4000, v2
    v_mfma_f32_16x16x32_bf16 v[248:251], v[40:43], v[8:11], v[248:251]
    v_xor_b32 v3, 0x4000, v3
    v_mfma_f32_16x16x32_bf16 v[252:255], v[44:47], v[8:11], v[252:255]
L_ST44:
    s_waitcnt lgkmcnt(1)
    v_mfma_f32_16x16x32_bf16 v[240:243], v[48:51], v[12:15], v[240:243]
    s_cbranch_scc0 L_NB6
    s_barrier
L_NB6:
    ds_read_b128 v[8:11], v1 offset:36864
    v_mfma_f32_16x16x32_bf16 v[244:247], v[52:55], v[12:15], v[244:247]
    v_mfma_f32_16x16x32_bf16 v[248:251], v[56:59], v[12:15], v[248:251]
    v_mfma_f32_16x16x32_bf16 v[252:255], v[60:63], v[12:15], v[252:255]
L_ST45:
    s_waitcnt lgkmcnt(1)
    v_mfma_f32_16x16x32_bf16 v[240:243], v[64:67], v[4:7], v[240:243]
    ds_read_b128 v[12:15], v1 offset:37888
    v_mfma_f32_16x16x32_bf16 v[244:247], v[68:71], v[4:7], v[244:247]
    v_mfma_f32_16x16x32_bf16 v[248:251], v[72:75], v[4:7], v[248:251]
    v_mfma_f32_16x16x32_bf16 v[252:255], v[76:79], v[4:7], v[252:255]
L_ST46:
    s_waitcnt lgkmcnt(1)
    v_mfma_f32_16x16x32_bf16 v[240:243], v[80:83], v[8:11], v[240:243]
    ds_read_b128 v[4:7], v1 offset:40960
    v_mfma_f32_16x16x32_bf16 v[244:247], v[84:87], v[8:11], v[244:247]
    v_mfma_f32_16x16x32_bf16 v[248:251], v[88:91], v[8:11], v[248:251]
    v_mfma_f32_16x16x32_bf16 v[252:255], v[92:95], v[8:11], v[252:255]
L_ST47:
    s_waitcnt lgkmcnt(1)
    v_mfma_f32_16x16x32_bf16 v[240:243], v[96:99], v[12:15], v[240:243]
    ds_read_b128 v[8:11], v1 offset:41984
    v_mfma_f32_16x16x32_bf16 v[244:247], v[100:103], v[12:15], v[244:247]
    v_mfma_f32_16x16x32_bf16 v[248:251], v[104:107], v[12:15], v[248:251]
    v_mfma_f32_16x16x32_bf16 v[252:255], v[108:111], v[12:15], v[252:255]
L_ST48:
    s_waitcnt lgkmcnt(1)
    v_mfma_f32_16x16x32_bf16 v[240:243], v[112:115], v[4:7], v[240:243]
    ds_read_b128 v[12:15], v1 offset:45056
    v_mfma_f32_16x16x32_bf16 v[244:247], v[116:119], v[4:7], v[244:247]
    v_mfma_f32_16x16x32_bf16 v[248:251], v[120:123], v[4:7], v[248:251]
    v_mfma_f32_16x16x32_bf16 v[252:255], v[124:127], v[4:7], v[252:255]
L_ST49:
    s_waitcnt lgkmcnt(1)
    v_mfma_f32_16x16x32_bf16 v[240:243], v[128:131], v[8:11], v[240:243]
    ds_read_b128 v[4:7], v1 offset:46080
    v_mfma_f32_16x16x32_bf16 v[244:247], v[132:135], v[8:11], v[244:247]
    v_mfma_f32_16x16x32_bf16 v[248:251], v[136:139], v[8:11], v[248:251]
    v_mfma_f32_16x16x32_bf16 v[252:255], v[140:143], v[8:11], v[252:255]
L_ST50:
    s_waitcnt lgkmcnt(1)
    v_mfma_f32_16x16x32_bf16 v[240:243], v[144:147], v[12:15], v[240:243]
    s_cbranch_scc1 L_NB3
    s_barrier
L_NB3:
    ds_read_b128 v[8:11], v1 offset:49152
    v_mfma_f32_16x16x32_bf16 v[244:247], v[148:151], v[12:15], v[244:247]
    v_mfma_f32_16x16x32_bf16 v[248:251], v[152:155], v[12:15], v[248:251]
    v_mfma_f32_16x16x32_bf16 v[252:255], v[156:159], v[12:15], v[252:255]
L_ST51:
    s_waitcnt lgkmcnt(1)
    v_mfma_f32_16x16x32_bf16 v[240:243], v[160:163], v[4:7], v[240:243]
    ds_read_b128 v[12:15], v1 offset:50176
    v_mfma_f32_16x16x32_bf16 v[244:247], v[164:167], v[4:7], v[244:247]
    v_mfma_f32_16x16x32_bf16 v[248:251], v[168:171], v[4:7], v[248:251]
    v_mfma_f32_16x16x32_bf16 v[252:255], v[172:175], v[4:7], v[252:255]
L_ST52:
    s_waitcnt lgkmcnt(1)
    v_mfma_f32_16x16x32_bf16 v[240:243], v[176:179], v[8:11], v[240:243]
    ds_read_b128 v[4:7], v1 offset:53248
    v_mfma_f32_16x16x32_bf16 v[244:247], v[180:183], v[8:11], v[244:247]
    v_mfma_f32_16x16x32_bf16 v[248:251], v[184:187], v[8:11], v[248:251]
    v_mfma_f32_16x16x32_bf16 v[252:255], v[188:191], v[8:11], v[252:255]
L_ST53:
    s_waitcnt lgkmcnt(1)
    v_mfma_f32_16x16x32_bf16 v[240:243], v[192:195], v[12:15], v[240:243]
    ds_read_b128 v[8:11], v1 offset:54272
    v_mfma_f32_16x16x32_bf16 v[244:247], v[196:199], v[12:15], v[244:247]
    v_mfma_f32_16x16x32_bf16 v[248:251], v[200:203], v[12:15], v[248:251]
    v_mfma_f32_16x16x32_bf16 v[252:255], v[204:207], v[12:15], v[252:255]
L_ST54:
    s_waitcnt lgkmcnt(1)
    v_mfma_f32_16x16x32_bf16 v[240:243], v[208:211], v[4:7], v[240:243]
    ds_read_b128 v[12:15], v0 offset:0
    v_mfma_f32_16x16x32_bf16 v[244:247], v[212:215], v[4:7], v[244:247]
    v_mfma_f32_16x16x32_bf16 v[248:251], v[216:219], v[4:7], v[248:251]
    v_mfma_f32_16x16x32_bf16 v[252:255], v[220:223], v[4:7], v[252:255]
L_ST55:
    s_waitcnt lgkmcnt(1)
    v_mfma_f32_16x16x32_bf16 v[240:243], v[224:227], v[8:11], v[240:243]
    ds_read_b128 v[4:7], v0 offset:1024
    v_mfma_f32_16x16x32_bf16 v[244:247], v[228:231], v[8:11], v[244:247]
    v_mfma_f32_16x16x32_bf16 v[248:251], v[232:235], v[8:11], v[248:251]
    v_mfma_f32_16x16x32_bf16 v[252:255], v[236:239], v[8:11], v[252:255]
L_ST56:
    s_waitcnt lgkmcnt(1)
    ds_write_b128 v2, v[240:243] offset:0
    v_mfma_f32_16x16x32_bf16 v[240:243], v[16:19], v[12:15], 0
    ds_read_b128 v[8:11], v0 offset:4096
    ds_write_b128 v3, v[244:247] offset:4096
    v_mfma_f32_16x16x32_bf16 v[244:247], v[20:23], v[12:15], 0
    ds_write_b128 v2, v[248:251] offset:8192
    v_mfma_f32_16x16x32_bf16 v[248:251], v[24:27], v[12:15], 0
    ds_write_b128 v3, v[252:255] offset:12288
    v_mfma_f32_16x16x32_bf16 v[252:255], v[28:31], v[12:15], 0
L_ST57:
    s_waitcnt lgkmcnt(5)
    v_mfma_f32_16x16x32_bf16 v[240:243], v[32:35], v[4:7], v[240:243]
    ds_read_b128 v[12:15], v0 offset:5120
    v_mfma_f32_16x16x32_bf16 v[244:247], v[36:39], v[4:7], v[244:247]
    v_xor_b32 v2, 0x4000, v2
    v_mfma_f32_16x16x32_bf16 v[248:251], v[40:43], v[4:7], v[248:251]
    v_xor_b32 v3, 0x4000, v3
    v_mfma_f32_16x16x32_bf16 v[252:255], v[44:47], v[4:7], v[252:255]
L_ST58:
    s_waitcnt lgkmcnt(1)
    v_mfma_f32_16x16x32_bf16 v[240:243], v[48:51], v[8:11], v[240:243]
    s_cbranch_scc0 L_NB7
    s_barrier
L_NB7:
    ds_read_b128 v[4:7], v0 offset:8192
    v_mfma_f32_16x16x32_bf16 v[244:247], v[52:55], v[8:11], v[244:247]
    v_mfma_f32_16x16x32_bf16 v[248:251], v[56:59], v[8:11], v[248:251]
    v_mfma_f32_16x16x32_bf16 v[252:255], v[60:63], v[8:11], v[252:255]
L_ST59:
    s_waitcnt lgkmcnt(1)
    v_mfma_f32_16x16x32_bf16 v[240:243], v[64:67], v[12:15], v[240:243]
    ds_read_b128 v[8:11], v0 offset:9216
    v_mfma_f32_16x16x32_bf16 v[244:247], v[68:71], v[12:15], v[244:247]
    v_mfma_f32_16x16x32_bf16 v[248:251], v[72:75], v[12:15], v[248:251]
    v_subrev_u32 v1, 28672, v1
    v_mfma_f32_16x16x32_bf16 v[252:255], v[76:79], v[12:15], v[252:255]
L_ST60:
    s_waitcnt lgkmcnt(1)
    v_mfma_f32_16x16x32_bf16 v[240:243], v[80:83], v[4:7], v[240:243]
    ds_read_b128 v[12:15], v0 offset:12288
    v_mfma_f32_16x16x32_bf16 v[244:247], v[84:87], v[4:7], v[244:247]
    v_mfma_f32_16x16x32_bf16 v[248:251], v[88:91], v[4:7], v[248:251]
    v_mfma_f32_16x16x32_bf16 v[252:255], v[92:95], v[4:7], v[252:255]
L_ST61:
    s_waitcnt lgkmcnt(1)
    v_mfma_f32_16x16x32_bf16 v[240:243], v[96:99], v[8:11], v[240:243]
    s_cbranch_scc1 L_NB4
    s_barrier
L_NB4:
    ds_read_b128 v[4:7], v0 offset:13312
    v_mfma_f32_16x16x32_bf16 v[244:247], v[100:103], v[8:11], v[244:247]
    v_mfma_f32_16x16x32_bf16 v[248:251], v[104:107], v[8:11], v[248:251]
    v_mfma_f32_16x16x32_bf16 v[252:255], v[108:111], v[8:11], v[252:255]
L_ST62:
    s_waitcnt lgkmcnt(1)
    v_mfma_f32_16x16x32_bf16 v[240:243], v[112:115], v[12:15], v[240:243]
    ds_read_b128 v[8:11], v0 offset:16384
    v_mfma_f32_16x16x32_bf16 v[244:247], v[116:119], v[12:15], v[244:247]
    v_mfma_f32_16x16x32_bf16 v[248:251], v[120:123], v[12:15], v[248:251]
    v_mfma_f32_16x16x32_bf16 v[252:255], v[124:127], v[12:15], v[252:255]
L_ST63:
    s_waitcnt lgkmcnt(1)
    v_mfma_f32_16x16x32_bf16 v[240:243], v[128:131], v[4:7], v[240:243]
    ds_read_b128 v[12:15], v0 offset:17408
    v_mfma_f32_16x16x32_bf16 v[244:247], v[132:135], v[4:7], v[244:247]
    v_mfma_f32_16x16x32_bf16 v[248:251], v[136:139], v[4:7], v[248:251]
    v_mfma_f32_16x16x32_bf16 v[252:255], v[140:143], v[4:7], v[252:255]
L_ST64:
    s_waitcnt lgkmcnt(1)
    v_mfma_f32_16x16x32_bf16 v[240:243], v[144:147], v[8:11], v[240:243]
    ds_read_b128 v[4:7], v0 offset:20480
    v_mfma_f32_16x16x32_bf16 v[244:247], v[148:151], v[8:11], v[244:247]
    v_mfma_f32_16x16x32_bf16 v[248:251], v[152:155], v[8:11], v[248:251]
    v_mfma_f32_16x16x32_bf16 v[252:255], v[156:159], v[8:11], v[252:255]
L_ST65:
    s_waitcnt lgkmcnt(1)
    v_mfma_f32_16x16x32_bf16 v[240:243], v[160:163], v[12:15], v[240:243]
    ds_read_b128 v[8:11], v0 offset:21504
    v_mfma_f32_16x16x32_bf16 v[244:247], v[164:167], v[12:15], v[244:247]
    v_mfma_f32_16x16x32_bf16 v[248:251], v[168:171], v[12:15], v[248:251]
    v_mfma_f32_16x16x32_bf16 v[252:255], v[172:175], v[12:15], v[252:255]
L_ST66:
    s_waitcnt lgkmcnt(1)
    v_mfma_f32_16x16x32_bf16 v[240:243], v[176:179], v[4:7], v[240:243]
    ds_read_b128 v[12:15], v0 offset:24576
    v_mfma_f32_16x16x32_bf16 v[244:247], v[180:183], v[4:7], v[244:247]
    v_mfma_f32_16x16x32_bf16 v[248:251], v[184:187], v[4:7], v[248:251]
    v_mfma_f32_16x16x32_bf16 v[252:255], v[188:191], v[4:7], v[252:255]
L_ST67:
    s_waitcnt lgkmcnt(1)
    v_mfma_f32_16x16x32_bf16 v[240:243], v[192:195], v[8:11], v[240:243]
    ds_read_b128 v[4:7], v0 offset:25600
    v_mfma_f32_16x16x32_bf16 v[244:247], v[196:199], v[8:11], v[244:247]
    v_mfma_f32_16x16x32_bf16 v[248:251], v[200:203], v[8:11], v[248:251]
    v_mfma_f32_16x16x32_bf16 v[252:255], v[204:207], v[8:11], v[252:255]
L_ST68:
    s_waitcnt lgkmcnt(1)
    v_mfma_f32_16x16x32_bf16 v[240:243], v[208:211], v[12:15], v[240:243]
    ds_read_b128 v[8:11], v1 offset:0
    v_mfma_f32_16x16x32_bf16 v[244:247], v[212:215], v[12:15], v[244:247]
    v_mfma_f32_16x16x32_bf16 v[248:251], v[216:219], v[12:15], v[248:251]
    v_mfma_f32_16x16x32_bf16 v[252:255], v[220:223], v[12:15], v[252:255]
L_ST69:
    s_waitcnt lgkmcnt(1)
    v_mfma_f32_16x16x32_bf16 v[240:243], v[224:227], v[4:7], v[240:243]
    ds_read_b128 v[12:15], v1 offset:1024
    v_mfma_f32_16x16x32_bf16 v[244:247], v[228:231], v[4:7], v[244:247]
    v_mfma_f32_16x16x32_bf16 v[248:251], v[232:235], v[4:7], v[248:251]
    v_add_u32 v0, 86016, v0
    v_mfma_f32_16x16x32_bf16 v[252:255], v[236:239], v[4:7], v[252:255]
    s_cbranch_scc1 L_LPX
    s_cmp_eq_u32 s0, s0
    s_branch L_ST28
L_LPX:
    ds_write_b128 v2, v[240:243] offset:0
    s_nop 2
    ds_write_b128 v3, v[244:247] offset:4096
    s_nop 2
    ds_write_b128 v2, v[248:251] offset:8192
    s_nop 2
    ds_write_b128 v3, v[252:255] offset:12288
    s_waitcnt lgkmcnt(0)
    s_barrier
    s_branch L_DONE
    .fill 492, 4, 0xbf810000
L_PAD_p2h:
    s_branch L_DISP
L_P2H:
    v_bfe_u32 v24, s61, 0, 8
    v_bfe_u32 v25, s61, 8, 8
    v_bfe_u32 v26, s61, 16, 8
    v_bfe_u32 v27, s61, 24, 8
    s_mov_b32 s62, 0x100000
L_PSW:
    ds_read_b32 v3, v15 offset:1024
    s_sub_u32 s62, s62, 1
    s_cbranch_scc1 L_PSX
    s_waitcnt lgkmcnt(0)
    v_cmp_ne_u32 vcc, 0, v3
    s_cbranch_vccnz L_PSX
    s_sleep 1
    s_branch L_PSW
L_PSX:
    s_add_u32 m0, s60, 106496
    s_add_u32 s53, s71, 118784
    buffer_load_dwordx4 v7, s[36:39], s53 offen sc1 lds
    s_add_u32 m0, s60, 110592
    s_add_u32 s53, s72, 118784
    buffer_load_dwordx4 v7, s[36:39], s53 offen sc1 lds
    s_add_u32 m0, s60, 114688
    s_add_u32 s53, s73, 118784
    buffer_load_dwordx4 v7, s[36:39], s53 offen sc1 lds
    s_add_u32 m0, s60, 118784
    s_add_u32 s53, s74, 118784
    buffer_load_dwordx4 v7, s[36:39], s53 offen sc1 lds
    s_add_u32 m0, s60, 122880
    s_add_u32 s53, s75, 118784
    buffer_load_dwordx4 v7, s[36:39], s53 offen sc1 lds
    s_add_u32 m0, s60, 126976
    s_add_u32 s53, s76, 118784
    buffer_load_dwordx4 v7, s[36:39], s53 offen sc1 lds
    s_add_u32 m0, s60, 131072
    s_add_u32 s53, s77, 118784
    buffer_load_dwordx4 v7, s[36:39], s53 offen sc1 lds
    s_barrier
    s_add_u32 m0, s60, 135168
    s_add_u32 s53, s71, 593920
    buffer_load_dwordx4 v7, s[36:39], s53 offen sc1 lds
    s_add_u32 m0, s60, 139264
    s_add_u32 s53, s72, 593920
    buffer_load_dwordx4 v7, s[36:39], s53 offen sc1 lds
    s_add_u32 m0, s60, 143360
    s_add_u32 s53, s73, 593920
    buffer_load_dwordx4 v7, s[36:39], s53 offen sc1 lds
    s_add_u32 m0, s60, 147456
    s_add_u32 s53, s74, 593920
    buffer_load_dwordx4 v7, s[36:39], s53 offen sc1 lds
    s_add_u32 m0, s60, 151552
    s_add_u32 s53, s75, 593920
    buffer_load_dwordx4 v7, s[36:39], s53 offen sc1 lds
    s_add_u32 m0, s60, 155648
    s_add_u32 s53, s76, 593920
    buffer_load_dwordx4 v7, s[36:39], s53 offen sc1 lds
    s_add_u32 m0, s60, 159744
    s_add_u32 s53, s77, 593920
    buffer_load_dwordx4 v7, s[36:39], s53 offen sc1 lds
    s_waitcnt vmcnt(7)
    ds_read_b32 v64, v12 offset:0
    ds_read_b32 v65, v12 offset:4096
    ds_read_b32 v66, v12 offset:8192
    ds_read_b32 v67, v12 offset:12288
    ds_read_b32 v68, v12 offset:16384
    ds_read_b32 v69, v12 offset:20480
    ds_read_b32 v70, v12 offset:24576
    s_waitcnt lgkmcnt(0)
    v_max3_u32 v3, v64, v65, v66
    v_max3_u32 v4, v67, v68, v69
    v_max3_u32 v3, v3, v4, v70
    v_cmp_eq_u32 vcc, -1, v3
    s_movk_i32 s62, 400
    s_cbranch_vccnz L_RH2
L_OKH2:
    s_waitcnt lgkmcnt(0)
    s_barrier
    ds_read_b128 v[32:35], v1 offset:0
    ds_read_b128 v[36:39], v1 offset:256
    ds_read_b128 v[40:43], v1 offset:2048
    ds_read_b128 v[44:47], v1 offset:2304
    s_add_u32 m0, s60, 49152
    s_add_u32 s53, s71, 237568
    buffer_load_dwordx4 v7, s[36:39], s53 offen sc1 lds
    s_add_u32 m0, s60, 53248
    s_add_u32 s53, s72, 237568
    buffer_load_dwordx4 v7, s[36:39], s53 offen sc1 lds
    s_add_u32 m0, s60, 57344
    s_add_u32 s53, s73, 237568
    buffer_load_dwordx4 v7, s[36:39], s53 offen sc1 lds
    s_add_u32 m0, s60, 61440
    s_add_u32 s53, s74, 237568
    buffer_load_dwordx4 v7, s[36:39], s53 offen sc1 lds
    s_add_u32 m0, s60, 65536
    s_add_u32 s53, s75, 237568
    buffer_load_dwordx4 v7, s[36:39], s53 offen sc1 lds
    s_add_u32 m0, s60, 69632
    s_add_u32 s53, s76, 237568
    buffer_load_dwordx4 v7, s[36:39], s53 offen sc1 lds
    s_add_u32 m0, s60, 73728
    s_add_u32 s53, s77, 237568
    buffer_load_dwordx4 v7, s[36:39], s53 offen sc1 lds
    s_waitcnt lgkmcnt(0)
    v_add_f32 v48, v32, v40
    v_add_f32 v49, v33, v41
    v_add_f32 v50, v34, v42
    v_add_f32 v51, v35, v43
    v_add_f32 v52, v36, v44
    v_add_f32 v53, v37, v45
    v_add_f32 v54, v38, v46
    v_add_f32 v55, v39, v47
    v_bfi_b32 v48, s11, v24, v48
    v_bfi_b32 v49, s11, v25, v49
    v_bfi_b32 v50, s11, v26, v50
    v_bfi_b32 v51, s11, v27, v51
    v_bfi_b32 v52, s11, v24, v52
    v_bfi_b32 v53, s11, v25, v53
    v_bfi_b32 v54, s11, v26, v54
    v_bfi_b32 v55, s11, v27, v55
    buffer_store_dwordx4 v[48:51], v7, s[36:39], s4 offen offset:0 sc1
    buffer_store_dwordx4 v[52:55], v7, s[36:39], s4 offen offset:1024 sc1
    s_waitcnt vmcnt(9)
    ds_read_b32 v64, v12 offset:28672
    ds_read_b32 v65, v12 offset:32768
    ds_read_b32 v66, v12 offset:36864
    ds_read_b32 v67, v12 offset:40960
    ds_read_b32 v68, v12 offset:45056
    ds_read_b32 v69, v12 offset:49152
    ds_read_b32 v70, v12 offset:53248
    s_waitcnt lgkmcnt(0)
    v_max3_u32 v3, v64, v65, v66
    v_max3_u32 v4, v67, v68, v69
    v_max3_u32 v3, v3, v4, v70
    v_cmp_eq_u32 vcc, -1, v3
    s_movk_i32 s62, 400
    s_cbranch_vccnz L_RH3
L_OKH3:
    s_waitcnt lgkmcnt(0)
    s_barrier
    ds_read_b128 v[32:35], v1 offset:16384
    ds_read_b128 v[36:39], v1 offset:16640
    ds_read_b128 v[40:43], v1 offset:18432
    ds_read_b128 v[44:47], v1 offset:18688
    s_add_u32 m0, s60, 77824
    s_add_u32 s53, s71, 712704
    buffer_load_dwordx4 v7, s[36:39], s53 offen sc1 lds
    s_add_u32 m0, s60, 81920
    s_add_u32 s53, s72, 712704
L_PAD_p2h.1:
    s_cbranch_execz L_RETL4
    buffer_load_dwordx4 v7, s[36:39], s53 offen sc1 lds
    s_add_u32 m0, s60, 86016
    s_add_u32 s53, s73, 712704
    buffer_load_dwordx4 v7, s[36:39], s53 offen sc1 lds
    s_add_u32 m0, s60, 90112
    s_add_u32 s53, s74, 712704
    buffer_load_dwordx4 v7, s[36:39], s53 offen sc1 lds
    s_add_u32 m0, s60, 94208
    s_add_u32 s53, s75, 712704
    buffer_load_dwordx4 v7, s[36:39], s53 offen sc1 lds
    s_add_u32 m0, s60, 98304
    s_add_u32 s53, s76, 712704
    buffer_load_dwordx4 v7, s[36:39], s53 offen sc1 lds
    s_add_u32 m0, s60, 102400
    s_add_u32 s53, s77, 712704
    buffer_load_dwordx4 v7, s[36:39], s53 offen sc1 lds
    s_waitcnt lgkmcnt(0)
    v_add_f32 v48, v32, v40
    v_add_f32 v49, v33, v41
    v_add_f32 v50, v34, v42
    v_add_f32 v51, v35, v43
    v_add_f32 v52, v36, v44
    v_add_f32 v53, v37, v45
    v_add_f32 v54, v38, v46
    v_add_f32 v55, v39, v47
    v_bfi_b32 v48, s11, v24, v48
    v_bfi_b32 v49, s11, v25, v49
    v_bfi_b32 v50, s11, v26, v50
    v_bfi_b32 v51, s11, v27, v51
    v_bfi_b32 v52, s11, v24, v52
    v_bfi_b32 v53, s11, v25, v53
    v_bfi_b32 v54, s11, v26, v54
    v_bfi_b32 v55, s11, v27, v55
    s_add_u32 s54, s4, 8192
    buffer_store_dwordx4 v[48:51], v7, s[36:39], s54 offen offset:0 sc1
    buffer_store_dwordx4 v[52:55], v7, s[36:39], s54 offen offset:1024 sc1
    v_mov_b32 v5, s61
    s_mov_b64 exec, 1
    buffer_store_dword v5, v10, s[32:35], s19 offen offset:64 sc1
    s_mov_b64 exec, -1
    s_waitcnt vmcnt(12)
    ds_read_b32 v64, v11 offset:0
    ds_read_b32 v65, v11 offset:4096
    ds_read_b32 v66, v11 offset:8192
    ds_read_b32 v67, v11 offset:12288
    ds_read_b32 v68, v11 offset:16384
    ds_read_b32 v69, v11 offset:20480
    ds_read_b32 v70, v11 offset:24576
    s_waitcnt lgkmcnt(0)
    v_max3_u32 v3, v64, v65, v66
    v_max3_u32 v4, v67, v68, v69
    v_max3_u32 v3, v3, v4, v70
    v_cmp_eq_u32 vcc, -1, v3
    s_movk_i32 s62, 400
    s_cbranch_vccnz L_RH4
L_OKH4:
    s_waitcnt lgkmcnt(0)
    s_barrier
    ds_read_b128 v[32:35], v1 offset:0
    ds_read_b128 v[36:39], v1 offset:256
    ds_read_b128 v[40:43], v1 offset:2048
    ds_read_b128 v[44:47], v1 offset:2304
    s_add_u32 m0, s60, 106496
    s_add_u32 s53, s71, 356352
    buffer_load_dwordx4 v7, s[36:39], s53 offen sc1 lds
    s_add_u32 m0, s60, 110592
    s_add_u32 s53, s72, 356352
    buffer_load_dwordx4 v7, s[36:39], s53 offen sc1 lds
    s_add_u32 m0, s60, 114688
    s_add_u32 s53, s73, 356352
    buffer_load_dwordx4 v7, s[36:39], s53 offen sc1 lds
    s_add_u32 m0, s60, 118784
    s_add_u32 s53, s74, 356352
    buffer_load_dwordx4 v7, s[36:39], s53 offen sc1 lds
    s_add_u32 m0, s60, 122880
    s_add_u32 s53, s75, 356352
    buffer_load_dwordx4 v7, s[36:39], s53 offen sc1 lds
    s_add_u32 m0, s60, 126976
    s_add_u32 s53, s76, 356352
    buffer_load_dwordx4 v7, s[36:39], s53 offen sc1 lds
    s_add_u32 m0, s60, 131072
    s_add_u32 s53, s77, 356352
    buffer_load_dwordx4 v7, s[36:39], s53 offen sc1 lds
    s_waitcnt lgkmcnt(0)
    v_add_f32 v48, v32, v40
    v_add_f32 v49, v33, v41
    v_add_f32 v50, v34, v42
    v_add_f32 v51, v35, v43
    v_add_f32 v52, v36, v44
    v_add_f32 v53, v37, v45
    v_add_f32 v54, v38, v46
    v_add_f32 v55, v39, v47
    v_bfi_b32 v48, s11, v24, v48
    v_bfi_b32 v49, s11, v25, v49
    v_bfi_b32 v50, s11, v26, v50
    v_bfi_b32 v51, s11, v27, v51
    v_bfi_b32 v52, s11, v24, v52
    v_bfi_b32 v53, s11, v25, v53
    v_bfi_b32 v54, s11, v26, v54
    v_bfi_b32 v55, s11, v27, v55
    buffer_store_dwordx4 v[48:51], v7, s[36:39], s5 offen offset:0 sc1
    buffer_store_dwordx4 v[52:55], v7, s[36:39], s5 offen offset:1024 sc1
    s_waitcnt vmcnt(12)
    ds_read_b32 v64, v11 offset:28672
    ds_read_b32 v65, v11 offset:32768
    ds_read_b32 v66, v11 offset:36864
    ds_read_b32 v67, v11 offset:40960
    ds_read_b32 v68, v11 offset:45056
    ds_read_b32 v69, v11 offset:49152
    ds_read_b32 v70, v11 offset:53248
    s_waitcnt lgkmcnt(0)
    v_max3_u32 v3, v64, v65, v66
    v_max3_u32 v4, v67, v68, v69
    v_max3_u32 v3, v3, v4, v70
    v_cmp_eq_u32 vcc, -1, v3
    s_movk_i32 s62, 400
    s_cbranch_vccnz L_RH5
L_OKH5:
    s_waitcnt lgkmcnt(0)
    s_barrier
    ds_read_b128 v[32:35], v1 offset:16384
    ds_read_b128 v[36:39], v1 offset:16640
    ds_read_b128 v[40:43], v1 offset:18432
    ds_read_b128 v[44:47], v1 offset:18688
    s_add_u32 m0, s60, 135168
    s_add_u32 s53, s71, 831488
    buffer_load_dwordx4 v7, s[36:39], s53 offen sc1 lds
    s_add_u32 m0, s60, 139264
    s_add_u32 s53, s72, 831488
    buffer_load_dwordx4 v7, s[36:39], s53 offen sc1 lds
    s_add_u32 m0, s60, 143360
    s_add_u32 s53, s73, 831488
    buffer_load_dwordx4 v7, s[36:39], s53 offen sc1 lds
    s_add_u32 m0, s60, 147456
    s_add_u32 s53, s74, 831488
    buffer_load_dwordx4 v7, s[36:39], s53 offen sc1 lds
    s_add_u32 m0, s60, 151552
    s_add_u32 s53, s75, 831488
    buffer_load_dwordx4 v7, s[36:39], s53 offen sc1 lds
    s_add_u32 m0, s60, 155648
    s_add_u32 s53, s76, 831488
    buffer_load_dwordx4 v7, s[36:39], s53 offen sc1 lds
    s_add_u32 m0, s60, 159744
    s_add_u32 s53, s77, 831488
    buffer_load_dwordx4 v7, s[36:39], s53 offen sc1 lds
    s_waitcnt lgkmcnt(0)
    v_add_f32 v48, v32, v40
    v_add_f32 v49, v33, v41
    v_add_f32 v50, v34, v42
L_PAD_p2h.2:
    s_cbranch_execz L_RETL4
    v_add_f32 v51, v35, v43
    v_add_f32 v52, v36, v44
    v_add_f32 v53, v37, v45
    v_add_f32 v54, v38, v46
    v_add_f32 v55, v39, v47
    v_bfi_b32 v48, s11, v24, v48
    v_bfi_b32 v49, s11, v25, v49
    v_bfi_b32 v50, s11, v26, v50
    v_bfi_b32 v51, s11, v27, v51
    v_bfi_b32 v52, s11, v24, v52
    v_bfi_b32 v53, s11, v25, v53
    v_bfi_b32 v54, s11, v26, v54
    v_bfi_b32 v55, s11, v27, v55
    s_add_u32 s54, s5, 8192
    buffer_store_dwordx4 v[48:51], v7, s[36:39], s54 offen offset:0 sc1
    buffer_store_dwordx4 v[52:55], v7, s[36:39], s54 offen offset:1024 sc1
    s_waitcnt vmcnt(11)
    ds_read_b32 v64, v12 offset:0
    ds_read_b32 v65, v12 offset:4096
    ds_read_b32 v66, v12 offset:8192
    ds_read_b32 v67, v12 offset:12288
    ds_read_b32 v68, v12 offset:16384
    ds_read_b32 v69, v12 offset:20480
    ds_read_b32 v70, v12 offset:24576
    s_waitcnt lgkmcnt(0)
    v_max3_u32 v3, v64, v65, v66
    v_max3_u32 v4, v67, v68, v69
    v_max3_u32 v3, v3, v4, v70
    v_cmp_eq_u32 vcc, -1, v3
    s_movk_i32 s62, 400
    s_cbranch_vccnz L_RH6
L_OKH6:
    s_add_u32 s53, s7, 0
    buffer_load_dwordx4 v[80:83], v7, s[36:39], s53 offen offset:0 sc1
    buffer_load_dwordx4 v[84:87], v7, s[36:39], s53 offen offset:1024 sc1
    s_waitcnt lgkmcnt(0)
    s_barrier
    ds_read_b128 v[32:35], v1 offset:0
    ds_read_b128 v[36:39], v1 offset:256
    ds_read_b128 v[40:43], v1 offset:2048
    ds_read_b128 v[44:47], v1 offset:2304
    s_waitcnt lgkmcnt(0)
    v_add_f32 v48, v32, v40
    v_add_f32 v49, v33, v41
    v_add_f32 v50, v34, v42
    v_add_f32 v51, v35, v43
    v_add_f32 v52, v36, v44
    v_add_f32 v53, v37, v45
    v_add_f32 v54, v38, v46
    v_add_f32 v55, v39, v47
    v_bfi_b32 v48, s11, v24, v48
    v_bfi_b32 v49, s11, v25, v49
    v_bfi_b32 v50, s11, v26, v50
    v_bfi_b32 v51, s11, v27, v51
    v_bfi_b32 v52, s11, v24, v52
    v_bfi_b32 v53, s11, v25, v53
    v_bfi_b32 v54, s11, v26, v54
    v_bfi_b32 v55, s11, v27, v55
    buffer_store_dwordx4 v[48:51], v7, s[36:39], s6 offen offset:0 sc1
    buffer_store_dwordx4 v[52:55], v7, s[36:39], s6 offen offset:1024 sc1
    s_add_u32 s53, s7, 8192
    buffer_load_dwordx4 v[88:91], v7, s[36:39], s53 offen offset:0 sc1
    buffer_load_dwordx4 v[92:95], v7, s[36:39], s53 offen offset:1024 sc1
    s_waitcnt vmcnt(8)
    ds_read_b32 v64, v12 offset:28672
    ds_read_b32 v65, v12 offset:32768
    ds_read_b32 v66, v12 offset:36864
    ds_read_b32 v67, v12 offset:40960
    ds_read_b32 v68, v12 offset:45056
    ds_read_b32 v69, v12 offset:49152
    ds_read_b32 v70, v12 offset:53248
    s_waitcnt lgkmcnt(0)
    v_max3_u32 v3, v64, v65, v66
    v_max3_u32 v4, v67, v68, v69
    v_max3_u32 v3, v3, v4, v70
    v_cmp_eq_u32 vcc, -1, v3
    s_movk_i32 s62, 400
    s_cbranch_vccnz L_RH7
L_OKH7:
    s_add_u32 s53, s7, 16384
    buffer_load_dwordx4 v[96:99], v7, s[36:39], s53 offen offset:0 sc1
    buffer_load_dwordx4 v[100:103], v7, s[36:39], s53 offen offset:1024 sc1
    s_waitcnt lgkmcnt(0)
    s_barrier
    ds_read_b128 v[32:35], v1 offset:16384
    ds_read_b128 v[36:39], v1 offset:16640
    ds_read_b128 v[40:43], v1 offset:18432
    ds_read_b128 v[44:47], v1 offset:18688
    s_waitcnt lgkmcnt(0)
    v_add_f32 v48, v32, v40
    v_add_f32 v49, v33, v41
    v_add_f32 v50, v34, v42
    v_add_f32 v51, v35, v43
    v_add_f32 v52, v36, v44
    v_add_f32 v53, v37, v45
    v_add_f32 v54, v38, v46
    v_add_f32 v55, v39, v47
    v_bfi_b32 v48, s11, v24, v48
    v_bfi_b32 v49, s11, v25, v49
    v_bfi_b32 v50, s11, v26, v50
    v_bfi_b32 v51, s11, v27, v51
    v_bfi_b32 v52, s11, v24, v52
    v_bfi_b32 v53, s11, v25, v53
    v_bfi_b32 v54, s11, v26, v54
    v_bfi_b32 v55, s11, v27, v55
    s_add_u32 s54, s6, 8192
    buffer_store_dwordx4 v[48:51], v7, s[36:39], s54 offen offset:0 sc1
    buffer_store_dwordx4 v[52:55], v7, s[36:39], s54 offen offset:1024 sc1
    s_add_u32 s53, s7, 24576
    buffer_load_dwordx4 v[104:107], v7, s[36:39], s53 offen offset:0 sc1
    buffer_load_dwordx4 v[108:111], v7, s[36:39], s53 offen offset:1024 sc1
    s_waitcnt vmcnt(10)
    v_xor_b32 v80, v24, v80
    v_xor_b32 v81, v25, v81
    v_xor_b32 v82, v26, v82
    v_xor_b32 v83, v27, v83
    v_xor_b32 v84, v24, v84
    v_xor_b32 v85, v25, v85
    v_xor_b32 v86, v26, v86
    v_xor_b32 v87, v27, v87
    v_or3_b32 v72, v80, v81, v82
    v_or3_b32 v72, v72, v83, v84
    v_or3_b32 v72, v72, v85, v86
    v_or_b32 v72, v72, v87
    s_waitcnt vmcnt(6)
    v_xor_b32 v88, v24, v88
    v_xor_b32 v89, v25, v89
    v_xor_b32 v90, v26, v90
    v_xor_b32 v91, v27, v91
    v_xor_b32 v92, v24, v92
    v_xor_b32 v93, v25, v93
    v_xor_b32 v94, v26, v94
    v_xor_b32 v95, v27, v95
    v_or3_b32 v73, v88, v89, v90
    v_or3_b32 v73, v73, v91, v92
    v_or3_b32 v73, v73, v93, v94
    v_or_b32 v73, v73, v95
    s_add_u32 s53, s7, 32768
    buffer_load_dwordx4 v[112:115], v7, s[36:39], s53 offen offset:0 sc1
    buffer_load_dwordx4 v[116:119], v7, s[36:39], s53 offen offset:1024 sc1
    s_waitcnt lgkmcnt(0)
    s_barrier
    ds_read_b128 v[32:35], v1 offset:0
    ds_read_b128 v[36:39], v1 offset:256
    ds_read_b128 v[40:43], v1 offset:2048
    ds_read_b128 v[44:47], v1 offset:2304
    s_add_u32 s53, s7, 40960
    buffer_load_dwordx4 v[120:123], v7, s[36:39], s53 offen offset:0 sc1
    buffer_load_dwordx4 v[124:127], v7, s[36:39], s53 offen offset:1024 sc1
    s_waitcnt lgkmcnt(0)
    v_add_f32 v56, v32, v40
    v_add_f32 v57, v33, v41
    v_add_f32 v58, v34, v42
    v_add_f32 v59, v35, v43
    v_add_f32 v60, v36, v44
    v_add_f32 v61, v37, v45
    v_add_f32 v62, v38, v46
    v_add_f32 v63, v39, v47
    s_waitcnt vmcnt(8)
    v_xor_b32 v96, v24, v96
    v_xor_b32 v97, v25, v97
    v_xor_b32 v98, v26, v98
    v_xor_b32 v99, v27, v99
    v_xor_b32 v100, v24, v100
    v_xor_b32 v101, v25, v101
    v_xor_b32 v102, v26, v102
    v_xor_b32 v103, v27, v103
    v_or3_b32 v72, v72, v96, v97
    v_or3_b32 v72, v72, v98, v99
L_PAD_p2h.3:
    s_cbranch_execz L_RETL4
    v_or3_b32 v72, v72, v100, v101
    v_or3_b32 v72, v72, v102, v103
    v_add_f32 v80, v80, v96
    v_add_f32 v81, v81, v97
    v_add_f32 v82, v82, v98
    v_add_f32 v83, v83, v99
    v_add_f32 v84, v84, v100
    v_add_f32 v85, v85, v101
    v_add_f32 v86, v86, v102
    v_add_f32 v87, v87, v103
    s_waitcnt vmcnt(4)
    v_xor_b32 v104, v24, v104
    v_xor_b32 v105, v25, v105
    v_xor_b32 v106, v26, v106
    v_xor_b32 v107, v27, v107
    v_xor_b32 v108, v24, v108
    v_xor_b32 v109, v25, v109
    v_xor_b32 v110, v26, v110
    v_xor_b32 v111, v27, v111
    v_or3_b32 v73, v73, v104, v105
    v_or3_b32 v73, v73, v106, v107
    v_or3_b32 v73, v73, v108, v109
    v_or3_b32 v73, v73, v110, v111
    v_add_f32 v88, v88, v104
    v_add_f32 v89, v89, v105
    v_add_f32 v90, v90, v106
    v_add_f32 v91, v91, v107
    v_add_f32 v92, v92, v108
    v_add_f32 v93, v93, v109
    v_add_f32 v94, v94, v110
    v_add_f32 v95, v95, v111
    s_add_u32 s53, s7, 40960
    buffer_load_dwordx4 v[240:243], v7, s[36:39], s53 offen offset:0 sc1
    buffer_load_dwordx4 v[244:247], v7, s[36:39], s53 offen offset:1024 sc1
    v_and_b32 v3, s11, v73
    v_cmp_ne_u32 vcc, 0, v3
    s_cbranch_vccnz L_SL1
L_SLX1:
    v_and_b32 v3, s11, v72
    v_cmp_ne_u32 vcc, 0, v3
    s_cbranch_vccnz L_SL0
L_SLX0:
    s_waitcnt vmcnt(4)
    v_xor_b32 v112, v24, v112
    v_xor_b32 v113, v25, v113
    v_xor_b32 v114, v26, v114
    v_xor_b32 v115, v27, v115
    v_xor_b32 v116, v24, v116
    v_xor_b32 v117, v25, v117
    v_xor_b32 v118, v26, v118
    v_xor_b32 v119, v27, v119
    v_or3_b32 v4, v112, v113, v114
    v_or3_b32 v4, v4, v115, v116
    v_or3_b32 v4, v4, v117, v118
    v_or_b32 v4, v4, v119
    v_and_b32 v3, s11, v4
    v_cmp_ne_u32 vcc, 0, v3
    s_cbranch_vccnz L_W
L_WX:
    v_add_f32 v80, v80, v112
    v_add_f32 v81, v81, v113
    v_add_f32 v82, v82, v114
    v_add_f32 v83, v83, v115
    v_add_f32 v84, v84, v116
    v_add_f32 v85, v85, v117
    v_add_f32 v86, v86, v118
    v_add_f32 v87, v87, v119
    v_add_f32 v80, v80, v56
    v_add_f32 v81, v81, v57
    v_add_f32 v82, v82, v58
    v_add_f32 v83, v83, v59
    v_add_f32 v84, v84, v60
    v_add_f32 v85, v85, v61
    v_add_f32 v86, v86, v62
    v_add_f32 v87, v87, v63
    v_cvt_pk_bf16_f32 v48, v80, v81
    v_cvt_pk_bf16_f32 v49, v82, v83
    v_cvt_pk_bf16_f32 v50, v84, v85
    v_cvt_pk_bf16_f32 v51, v86, v87
    buffer_store_dwordx4 v[48:51], v0, s[40:43], s8 offen
    s_add_u32 s8, s8, 131072
    s_barrier
    ds_read_b128 v[32:35], v1 offset:16384
    ds_read_b128 v[36:39], v1 offset:16640
    ds_read_b128 v[40:43], v1 offset:18432
    ds_read_b128 v[44:47], v1 offset:18688
    s_waitcnt vmcnt(3)
    v_xor_b32 v120, v24, v120
    v_xor_b32 v121, v25, v121
    v_xor_b32 v122, v26, v122
    v_xor_b32 v123, v27, v123
    v_xor_b32 v124, v24, v124
    v_xor_b32 v125, v25, v125
    v_xor_b32 v126, v26, v126
    v_xor_b32 v127, v27, v127
    v_or3_b32 v4, v120, v121, v122
    v_or3_b32 v4, v4, v123, v124
    v_or3_b32 v4, v4, v125, v126
    v_or_b32 v4, v4, v127
    v_and_b32 v3, s11, v4
    v_cmp_ne_u32 vcc, 0, v3
    v_add_f32 v120, v120, v88
    v_add_f32 v121, v121, v89
    v_add_f32 v122, v122, v90
    v_add_f32 v123, v123, v91
    v_add_f32 v124, v124, v92
    v_add_f32 v125, v125, v93
    v_add_f32 v126, v126, v94
    v_add_f32 v127, v127, v95
    s_waitcnt lgkmcnt(0)
    v_add_f32 v56, v32, v40
    v_add_f32 v57, v33, v41
    v_add_f32 v58, v34, v42
    v_add_f32 v59, v35, v43
    v_add_f32 v60, v36, v44
    v_add_f32 v61, v37, v45
    v_add_f32 v62, v38, v46
    v_add_f32 v63, v39, v47
    s_cbranch_vccnz L_Y
L_X2:
    v_add_f32 v120, v120, v56
    v_add_f32 v121, v121, v57
    v_add_f32 v122, v122, v58
    v_add_f32 v123, v123, v59
    v_add_f32 v124, v124, v60
    v_add_f32 v125, v125, v61
    v_add_f32 v126, v126, v62
    v_add_f32 v127, v127, v63
    v_cvt_pk_bf16_f32 v48, v120, v121
    v_cvt_pk_bf16_f32 v49, v122, v123
    v_cvt_pk_bf16_f32 v50, v124, v125
    v_cvt_pk_bf16_f32 v51, v126, v127
    buffer_store_dwordx4 v[48:51], v0, s[40:43], s8 offen
L_DONE:
L_END:
    s_endpgm
    .fill 14, 4, 0xbf810000
L_GD:
    v_readfirstlane_b32 s61, v8
    s_mov_b32 s62, 0x40000
GD_TL:
    s_cmp_lg_u32 s61, 0
    s_cbranch_scc1 GD_TOK
    s_sub_u32 s62, s62, 1
    s_cbranch_scc1 GD_TOK
    buffer_load_dword v8, v10, s[44:47], 0 offen sc1
    s_waitcnt vmcnt(0)
    v_readfirstlane_b32 s61, v8
    s_branch GD_TL
GD_TOK:
    s_mov_b32 s62, 0x20000
    s_mov_b64 exec, 0x3fff
L_POLLGD:
    buffer_load_dword v3, v9, s[36:39], 0 offen offset:128 sc1
    s_waitcnt vmcnt(0)
L_PCGD:
    v_cmp_ne_u32 vcc, s61, v3
    s_cbranch_vccz L_GOGD
    s_sub_u32 s62, s62, 1
    s_cbranch_scc1 L_GOGD
    s_sleep 4
    s_branch L_POLLGD
L_GOGD:
    s_mov_b64 exec, -1
    s_branch L_GDR
L_RC1:
    s_sub_u32 s62, s62, 1
    s_cbranch_scc1 L_FBC1
    v_cmp_eq_u32 vcc, -1, v64
    s_cbranch_vccz L_SC1_0
    s_add_u32 m0, s60, 77824
    s_add_u32 s53, s71, 475136
    buffer_load_dwordx4 v7, s[36:39], s53 offen sc1 lds
L_SC1_0:
    v_cmp_eq_u32 vcc, -1, v65
    s_cbranch_vccz L_SC1_1
    s_add_u32 m0, s60, 81920
    s_add_u32 s53, s72, 475136
    buffer_load_dwordx4 v7, s[36:39], s53 offen sc1 lds
L_SC1_1:
    v_cmp_eq_u32 vcc, -1, v66
    s_cbranch_vccz L_SC1_2
    s_add_u32 m0, s60, 86016
    s_add_u32 s53, s73, 475136
    buffer_load_dwordx4 v7, s[36:39], s53 offen sc1 lds
L_SC1_2:
    v_cmp_eq_u32 vcc, -1, v67
    s_cbranch_vccz L_SC1_3
    s_add_u32 m0, s60, 90112
    s_add_u32 s53, s74, 475136
    buffer_load_dwordx4 v7, s[36:39], s53 offen sc1 lds
L_SC1_3:
    v_cmp_eq_u32 vcc, -1, v68
    s_cbranch_vccz L_SC1_4
    s_add_u32 m0, s60, 94208
    s_add_u32 s53, s75, 475136
    buffer_load_dwordx4 v7, s[36:39], s53 offen sc1 lds
L_SC1_4:
    v_cmp_eq_u32 vcc, -1, v69
    s_cbranch_vccz L_SC1_5
    s_add_u32 m0, s60, 98304
    s_add_u32 s53, s76, 475136
    buffer_load_dwordx4 v7, s[36:39], s53 offen sc1 lds
L_SC1_5:
    v_cmp_eq_u32 vcc, -1, v70
    s_cbranch_vccz L_SC1_6
    s_add_u32 m0, s60, 102400
    s_add_u32 s53, s77, 475136
    buffer_load_dwordx4 v7, s[36:39], s53 offen sc1 lds
L_SC1_6:
    s_waitcnt vmcnt(0)
    ds_read_b32 v64, v11 offset:28672
    ds_read_b32 v65, v11 offset:32768
    ds_read_b32 v66, v11 offset:36864
    ds_read_b32 v67, v11 offset:40960
    ds_read_b32 v68, v11 offset:45056
    ds_read_b32 v69, v11 offset:49152
    ds_read_b32 v70, v11 offset:53248
    s_waitcnt lgkmcnt(0)
    v_max3_u32 v3, v64, v65, v66
    v_max3_u32 v4, v67, v68, v69
    v_max3_u32 v3, v3, v4, v70
    v_cmp_eq_u32 vcc, -1, v3
    s_cbranch_vccnz L_RC1
    s_branch L_OKC1
L_FBC1:
    s_mov_b32 s62, 0x20000
    s_mov_b64 exec, 0x3fff
L_POLLFC1:
    buffer_load_dword v3, v9, s[36:39], 0 offen offset:0 sc1
    s_waitcnt vmcnt(0)
L_PCFC1:
    v_cmp_ne_u32 vcc, s61, v3
    s_cbranch_vccz L_GOFC1
    s_sub_u32 s62, s62, 1
    s_cbranch_scc1 L_GOFC1
    s_sleep 4
    s_branch L_POLLFC1
L_GOFC1:
    s_mov_b64 exec, -1
    s_add_u32 m0, s60, 77824
    s_add_u32 s53, s71, 475136
    buffer_load_dwordx4 v7, s[36:39], s53 offen sc1 lds
    s_add_u32 m0, s60, 81920
    s_add_u32 s53, s72, 475136
    buffer_load_dwordx4 v7, s[36:39], s53 offen sc1 lds
    s_add_u32 m0, s60, 86016
    s_add_u32 s53, s73, 475136
    buffer_load_dwordx4 v7, s[36:39], s53 offen sc1 lds
    s_add_u32 m0, s60, 90112
    s_add_u32 s53, s74, 475136
    buffer_load_dwordx4 v7, s[36:39], s53 offen sc1 lds
    s_add_u32 m0, s60, 94208
    s_add_u32 s53, s75, 475136
    buffer_load_dwordx4 v7, s[36:39], s53 offen sc1 lds
    s_add_u32 m0, s60, 98304
    s_add_u32 s53, s76, 475136
    buffer_load_dwordx4 v7, s[36:39], s53 offen sc1 lds
    s_add_u32 m0, s60, 102400
    s_add_u32 s53, s77, 475136
    buffer_load_dwordx4 v7, s[36:39], s53 offen sc1 lds
    s_waitcnt vmcnt(0)
    s_branch L_OKC1
L_RS1:
    s_sub_u32 s62, s62, 1
    s_cbranch_scc1 L_FBS1
    v_cmp_eq_u32 vcc, -1, v64
    s_cbranch_vccz L_SS1_0
    s_add_u32 m0, s60, 77824
    s_add_u32 s53, s71, 475136
    buffer_load_dwordx4 v7, s[36:39], s53 offen sc1 lds
L_SS1_0:
    v_cmp_eq_u32 vcc, -1, v65
    s_cbranch_vccz L_SS1_1
    s_add_u32 m0, s60, 81920
    s_add_u32 s53, s72, 475136
    buffer_load_dwordx4 v7, s[36:39], s53 offen sc1 lds
L_SS1_1:
    v_cmp_eq_u32 vcc, -1, v66
    s_cbranch_vccz L_SS1_2
    s_add_u32 m0, s60, 86016
    s_add_u32 s53, s73, 475136
    buffer_load_dwordx4 v7, s[36:39], s53 offen sc1 lds
L_SS1_2:
    v_cmp_eq_u32 vcc, -1, v67
    s_cbranch_vccz L_SS1_3
    s_add_u32 m0, s60, 90112
    s_add_u32 s53, s74, 475136
    buffer_load_dwordx4 v7, s[36:39], s53 offen sc1 lds
L_SS1_3:
    v_cmp_eq_u32 vcc, -1, v68
    s_cbranch_vccz L_SS1_4
    s_add_u32 m0, s60, 94208
    s_add_u32 s53, s75, 475136
    buffer_load_dwordx4 v7, s[36:39], s53 offen sc1 lds
L_SS1_4:
    v_cmp_eq_u32 vcc, -1, v69
    s_cbranch_vccz L_SS1_5
    s_add_u32 m0, s60, 98304
    s_add_u32 s53, s76, 475136
    buffer_load_dwordx4 v7, s[36:39], s53 offen sc1 lds
L_SS1_5:
    v_cmp_eq_u32 vcc, -1, v70
    s_cbranch_vccz L_SS1_6
    s_add_u32 m0, s60, 102400
    s_add_u32 s53, s77, 475136
    buffer_load_dwordx4 v7, s[36:39], s53 offen sc1 lds
L_SS1_6:
    s_waitcnt vmcnt(0)
    ds_read_b32 v64, v11 offset:28672
    ds_read_b32 v65, v11 offset:32768
    ds_read_b32 v66, v11 offset:36864
    ds_read_b32 v67, v11 offset:40960
    ds_read_b32 v68, v11 offset:45056
    ds_read_b32 v69, v11 offset:49152
    ds_read_b32 v70, v11 offset:53248
    s_waitcnt lgkmcnt(0)
    v_max3_u32 v3, v64, v65, v66
    v_max3_u32 v4, v67, v68, v69
    v_max3_u32 v3, v3, v4, v70
    v_cmp_eq_u32 vcc, -1, v3
    s_cbranch_vccnz L_RS1
    s_branch L_OKS1
L_FBS1:
    s_mov_b32 s62, 0x20000
    s_mov_b64 exec, 0x3fff
L_POLLFS1:
    buffer_load_dword v3, v9, s[36:39], 0 offen offset:0 sc1
    s_waitcnt vmcnt(0)
L_PCFS1:
    v_cmp_ne_u32 vcc, s61, v3
    s_cbranch_vccz L_GOFS1
    s_sub_u32 s62, s62, 1
    s_cbranch_scc1 L_GOFS1
    s_sleep 4
    s_branch L_POLLFS1
L_GOFS1:
    s_mov_b64 exec, -1
    s_add_u32 m0, s60, 77824
    s_add_u32 s53, s71, 475136
    buffer_load_dwordx4 v7, s[36:39], s53 offen sc1 lds
    s_add_u32 m0, s60, 81920
    s_add_u32 s53, s72, 475136
    buffer_load_dwordx4 v7, s[36:39], s53 offen sc1 lds
    s_add_u32 m0, s60, 86016
    s_add_u32 s53, s73, 475136
    buffer_load_dwordx4 v7, s[36:39], s53 offen sc1 lds
    s_add_u32 m0, s60, 90112
    s_add_u32 s53, s74, 475136
    buffer_load_dwordx4 v7, s[36:39], s53 offen sc1 lds
    s_add_u32 m0, s60, 94208
    s_add_u32 s53, s75, 475136
    buffer_load_dwordx4 v7, s[36:39], s53 offen sc1 lds
    s_add_u32 m0, s60, 98304
    s_add_u32 s53, s76, 475136
    buffer_load_dwordx4 v7, s[36:39], s53 offen sc1 lds
    s_add_u32 m0, s60, 102400
    s_add_u32 s53, s77, 475136
    buffer_load_dwordx4 v7, s[36:39], s53 offen sc1 lds
    s_waitcnt vmcnt(0)
    s_branch L_OKS1
L_RM0:
    s_sub_u32 s62, s62, 1
    s_cbranch_scc1 L_FBM0
    v_cmp_eq_u32 vcc, -1, v240
    s_cbranch_vccz L_SM0_0
    s_add_u32 m0, s60, 49152
    s_add_u32 s53, s71, 0
    buffer_load_dwordx4 v7, s[36:39], s53 offen sc1 lds
L_SM0_0:
    v_cmp_eq_u32 vcc, -1, v241
    s_cbranch_vccz L_SM0_1
    s_add_u32 m0, s60, 53248
    s_add_u32 s53, s72, 0
    buffer_load_dwordx4 v7, s[36:39], s53 offen sc1 lds
L_SM0_1:
    v_cmp_eq_u32 vcc, -1, v242
    s_cbranch_vccz L_SM0_2
    s_add_u32 m0, s60, 57344
    s_add_u32 s53, s73, 0
    buffer_load_dwordx4 v7, s[36:39], s53 offen sc1 lds
L_SM0_2:
    v_cmp_eq_u32 vcc, -1, v243
    s_cbranch_vccz L_SM0_3
    s_add_u32 m0, s60, 61440
    s_add_u32 s53, s74, 0
    buffer_load_dwordx4 v7, s[36:39], s53 offen sc1 lds
L_SM0_3:
    v_cmp_eq_u32 vcc, -1, v244
    s_cbranch_vccz L_SM0_4
    s_add_u32 m0, s60, 65536
    s_add_u32 s53, s75, 0
    buffer_load_dwordx4 v7, s[36:39], s53 offen sc1 lds
L_SM0_4:
    v_cmp_eq_u32 vcc, -1, v245
    s_cbranch_vccz L_SM0_5
    s_add_u32 m0, s60, 69632
    s_add_u32 s53, s76, 0
    buffer_load_dwordx4 v7, s[36:39], s53 offen sc1 lds
L_SM0_5:
    v_cmp_eq_u32 vcc, -1, v246
    s_cbranch_vccz L_SM0_6
    s_add_u32 m0, s60, 73728
    s_add_u32 s53, s77, 0
    buffer_load_dwordx4 v7, s[36:39], s53 offen sc1 lds
L_SM0_6:
    s_waitcnt vmcnt(0)
    ds_read_b32 v240, v11 offset:0
    ds_read_b32 v241, v11 offset:4096
    ds_read_b32 v242, v11 offset:8192
    ds_read_b32 v243, v11 offset:12288
    ds_read_b32 v244, v11 offset:16384
    ds_read_b32 v245, v11 offset:20480
    ds_read_b32 v246, v11 offset:24576
    s_waitcnt lgkmcnt(0)
    v_max3_u32 v3, v240, v241, v242
    v_max3_u32 v4, v243, v244, v245
    v_max3_u32 v3, v3, v4, v246
    v_cmp_eq_u32 vcc, -1, v3
    s_cbranch_vccnz L_RM0
    s_branch L_OKM0
L_FBM0:
    s_mov_b32 s62, 0x20000
    s_mov_b64 exec, 0x3fff
L_POLLFM0:
    buffer_load_dword v3, v9, s[36:39], 0 offen offset:0 sc1
    s_waitcnt vmcnt(0)
L_PCFM0:
    v_cmp_ne_u32 vcc, s61, v3
    s_cbranch_vccz L_GOFM0
    s_sub_u32 s62, s62, 1
    s_cbranch_scc1 L_GOFM0
    s_sleep 4
    s_branch L_POLLFM0
L_GOFM0:
    s_mov_b64 exec, -1
    s_add_u32 m0, s60, 49152
    s_add_u32 s53, s71, 0
    buffer_load_dwordx4 v7, s[36:39], s53 offen sc1 lds
    s_add_u32 m0, s60, 53248
    s_add_u32 s53, s72, 0
    buffer_load_dwordx4 v7, s[36:39], s53 offen sc1 lds
    s_add_u32 m0, s60, 57344
    s_add_u32 s53, s73, 0
    buffer_load_dwordx4 v7, s[36:39], s53 offen sc1 lds
    s_add_u32 m0, s60, 61440
    s_add_u32 s53, s74, 0
    buffer_load_dwordx4 v7, s[36:39], s53 offen sc1 lds
    s_add_u32 m0, s60, 65536
    s_add_u32 s53, s75, 0
    buffer_load_dwordx4 v7, s[36:39], s53 offen sc1 lds
    s_add_u32 m0, s60, 69632
    s_add_u32 s53, s76, 0
    buffer_load_dwordx4 v7, s[36:39], s53 offen sc1 lds
    s_add_u32 m0, s60, 73728
    s_add_u32 s53, s77, 0
    buffer_load_dwordx4 v7, s[36:39], s53 offen sc1 lds
    s_waitcnt vmcnt(0)
    s_branch L_OKM0
L_RH2:
    s_sub_u32 s62, s62, 1
    s_cbranch_scc1 L_FBH2
    v_cmp_eq_u32 vcc, -1, v64
    s_cbranch_vccz L_SH2_0
    s_add_u32 m0, s60, 106496
    s_add_u32 s53, s71, 118784
    buffer_load_dwordx4 v7, s[36:39], s53 offen sc1 lds
L_SH2_0:
    v_cmp_eq_u32 vcc, -1, v65
    s_cbranch_vccz L_SH2_1
    s_add_u32 m0, s60, 110592
    s_add_u32 s53, s72, 118784
    buffer_load_dwordx4 v7, s[36:39], s53 offen sc1 lds
L_SH2_1:
    v_cmp_eq_u32 vcc, -1, v66
    s_cbranch_vccz L_SH2_2
    s_add_u32 m0, s60, 114688
    s_add_u32 s53, s73, 118784
    buffer_load_dwordx4 v7, s[36:39], s53 offen sc1 lds
L_SH2_2:
    v_cmp_eq_u32 vcc, -1, v67
    s_cbranch_vccz L_SH2_3
    s_add_u32 m0, s60, 118784
    s_add_u32 s53, s74, 118784
    buffer_load_dwordx4 v7, s[36:39], s53 offen sc1 lds
L_SH2_3:
    v_cmp_eq_u32 vcc, -1, v68
    s_cbranch_vccz L_SH2_4
    s_add_u32 m0, s60, 122880
    s_add_u32 s53, s75, 118784
    buffer_load_dwordx4 v7, s[36:39], s53 offen sc1 lds
L_SH2_4:
    v_cmp_eq_u32 vcc, -1, v69
    s_cbranch_vccz L_SH2_5
    s_add_u32 m0, s60, 126976
    s_add_u32 s53, s76, 118784
    buffer_load_dwordx4 v7, s[36:39], s53 offen sc1 lds
L_SH2_5:
    v_cmp_eq_u32 vcc, -1, v70
    s_cbranch_vccz L_SH2_6
    s_add_u32 m0, s60, 131072
    s_add_u32 s53, s77, 118784
    buffer_load_dwordx4 v7, s[36:39], s53 offen sc1 lds
L_SH2_6:
    s_waitcnt vmcnt(0)
    ds_read_b32 v64, v12 offset:0
    ds_read_b32 v65, v12 offset:4096
    ds_read_b32 v66, v12 offset:8192
    ds_read_b32 v67, v12 offset:12288
    ds_read_b32 v68, v12 offset:16384
    ds_read_b32 v69, v12 offset:20480
    ds_read_b32 v70, v12 offset:24576
    s_waitcnt lgkmcnt(0)
    v_max3_u32 v3, v64, v65, v66
    v_max3_u32 v4, v67, v68, v69
    v_max3_u32 v3, v3, v4, v70
    v_cmp_eq_u32 vcc, -1, v3
    s_cbranch_vccnz L_RH2
    s_branch L_OKH2
L_FBH2:
    s_mov_b32 s62, 0x20000
    s_mov_b64 exec, 0x3fff
L_POLLFH2:
    buffer_load_dword v3, v9, s[36:39], 0 offen offset:0 sc1
    s_waitcnt vmcnt(0)
L_PCFH2:
    v_cmp_ne_u32 vcc, s61, v3
    s_cbranch_vccz L_GOFH2
    s_sub_u32 s62, s62, 1
    s_cbranch_scc1 L_GOFH2
    s_sleep 4
    s_branch L_POLLFH2
L_GOFH2:
    s_mov_b64 exec, -1
    s_add_u32 m0, s60, 106496
    s_add_u32 s53, s71, 118784
    buffer_load_dwordx4 v7, s[36:39], s53 offen sc1 lds
    s_add_u32 m0, s60, 110592
    s_add_u32 s53, s72, 118784
    buffer_load_dwordx4 v7, s[36:39], s53 offen sc1 lds
    s_add_u32 m0, s60, 114688
    s_add_u32 s53, s73, 118784
    buffer_load_dwordx4 v7, s[36:39], s53 offen sc1 lds
    s_add_u32 m0, s60, 118784
    s_add_u32 s53, s74, 118784
    buffer_load_dwordx4 v7, s[36:39], s53 offen sc1 lds
    s_add_u32 m0, s60, 122880
    s_add_u32 s53, s75, 118784
    buffer_load_dwordx4 v7, s[36:39], s53 offen sc1 lds
    s_add_u32 m0, s60, 126976
    s_add_u32 s53, s76, 118784
    buffer_load_dwordx4 v7, s[36:39], s53 offen sc1 lds
    s_add_u32 m0, s60, 131072
    s_add_u32 s53, s77, 118784
    buffer_load_dwordx4 v7, s[36:39], s53 offen sc1 lds
    s_waitcnt vmcnt(0)
    s_branch L_OKH2
L_RH3:
    s_sub_u32 s62, s62, 1
    s_cbranch_scc1 L_FBH3
    v_cmp_eq_u32 vcc, -1, v64
    s_cbranch_vccz L_SH3_0
    s_add_u32 m0, s60, 135168
    s_add_u32 s53, s71, 593920
    buffer_load_dwordx4 v7, s[36:39], s53 offen sc1 lds
L_SH3_0:
    v_cmp_eq_u32 vcc, -1, v65
    s_cbranch_vccz L_SH3_1
    s_add_u32 m0, s60, 139264
    s_add_u32 s53, s72, 593920
    buffer_load_dwordx4 v7, s[36:39], s53 offen sc1 lds
L_SH3_1:
    v_cmp_eq_u32 vcc, -1, v66
    s_cbranch_vccz L_SH3_2
    s_add_u32 m0, s60, 143360
    s_add_u32 s53, s73, 593920
    buffer_load_dwordx4 v7, s[36:39], s53 offen sc1 lds
L_SH3_2:
    v_cmp_eq_u32 vcc, -1, v67
    s_cbranch_vccz L_SH3_3
    s_add_u32 m0, s60, 147456
    s_add_u32 s53, s74, 593920
    buffer_load_dwordx4 v7, s[36:39], s53 offen sc1 lds
L_SH3_3:
    v_cmp_eq_u32 vcc, -1, v68
    s_cbranch_vccz L_SH3_4
    s_add_u32 m0, s60, 151552
    s_add_u32 s53, s75, 593920
    buffer_load_dwordx4 v7, s[36:39], s53 offen sc1 lds
L_SH3_4:
    v_cmp_eq_u32 vcc, -1, v69
    s_cbranch_vccz L_SH3_5
    s_add_u32 m0, s60, 155648
    s_add_u32 s53, s76, 593920
    buffer_load_dwordx4 v7, s[36:39], s53 offen sc1 lds
L_SH3_5:
    v_cmp_eq_u32 vcc, -1, v70
    s_cbranch_vccz L_SH3_6
    s_add_u32 m0, s60, 159744
    s_add_u32 s53, s77, 593920
    buffer_load_dwordx4 v7, s[36:39], s53 offen sc1 lds
L_SH3_6:
    s_waitcnt vmcnt(0)
    ds_read_b32 v64, v12 offset:28672
    ds_read_b32 v65, v12 offset:32768
    ds_read_b32 v66, v12 offset:36864
    ds_read_b32 v67, v12 offset:40960
    ds_read_b32 v68, v12 offset:45056
    ds_read_b32 v69, v12 offset:49152
    ds_read_b32 v70, v12 offset:53248
    s_waitcnt lgkmcnt(0)
    v_max3_u32 v3, v64, v65, v66
    v_max3_u32 v4, v67, v68, v69
    v_max3_u32 v3, v3, v4, v70
    v_cmp_eq_u32 vcc, -1, v3
    s_cbranch_vccnz L_RH3
    s_branch L_OKH3
L_FBH3:
    s_mov_b32 s62, 0x20000
    s_mov_b64 exec, 0x3fff
L_POLLFH3:
    buffer_load_dword v3, v9, s[36:39], 0 offen offset:0 sc1
    s_waitcnt vmcnt(0)
L_PCFH3:
    v_cmp_ne_u32 vcc, s61, v3
    s_cbranch_vccz L_GOFH3
    s_sub_u32 s62, s62, 1
    s_cbranch_scc1 L_GOFH3
    s_sleep 4
    s_branch L_POLLFH3
L_GOFH3:
    s_mov_b64 exec, -1
    s_add_u32 m0, s60, 135168
    s_add_u32 s53, s71, 593920
    buffer_load_dwordx4 v7, s[36:39], s53 offen sc1 lds
    s_add_u32 m0, s60, 139264
    s_add_u32 s53, s72, 593920
    buffer_load_dwordx4 v7, s[36:39], s53 offen sc1 lds
    s_add_u32 m0, s60, 143360
    s_add_u32 s53, s73, 593920
    buffer_load_dwordx4 v7, s[36:39], s53 offen sc1 lds
    s_add_u32 m0, s60, 147456
    s_add_u32 s53, s74, 593920
    buffer_load_dwordx4 v7, s[36:39], s53 offen sc1 lds
    s_add_u32 m0, s60, 151552
    s_add_u32 s53, s75, 593920
    buffer_load_dwordx4 v7, s[36:39], s53 offen sc1 lds
    s_add_u32 m0, s60, 155648
    s_add_u32 s53, s76, 593920
    buffer_load_dwordx4 v7, s[36:39], s53 offen sc1 lds
    s_add_u32 m0, s60, 159744
    s_add_u32 s53, s77, 593920
    buffer_load_dwordx4 v7, s[36:39], s53 offen sc1 lds
    s_waitcnt vmcnt(0)
    s_branch L_OKH3
L_RH4:
    s_sub_u32 s62, s62, 1
    s_cbranch_scc1 L_FBH4
    v_cmp_eq_u32 vcc, -1, v64
    s_cbranch_vccz L_SH4_0
    s_add_u32 m0, s60, 49152
    s_add_u32 s53, s71, 237568
    buffer_load_dwordx4 v7, s[36:39], s53 offen sc1 lds
L_SH4_0:
    v_cmp_eq_u32 vcc, -1, v65
    s_cbranch_vccz L_SH4_1
    s_add_u32 m0, s60, 53248
    s_add_u32 s53, s72, 237568
    buffer_load_dwordx4 v7, s[36:39], s53 offen sc1 lds
L_SH4_1:
    v_cmp_eq_u32 vcc, -1, v66
    s_cbranch_vccz L_SH4_2
    s_add_u32 m0, s60, 57344
    s_add_u32 s53, s73, 237568
    buffer_load_dwordx4 v7, s[36:39], s53 offen sc1 lds
L_SH4_2:
    v_cmp_eq_u32 vcc, -1, v67
    s_cbranch_vccz L_SH4_3
    s_add_u32 m0, s60, 61440
    s_add_u32 s53, s74, 237568
    buffer_load_dwordx4 v7, s[36:39], s53 offen sc1 lds
L_SH4_3:
    v_cmp_eq_u32 vcc, -1, v68
    s_cbranch_vccz L_SH4_4
    s_add_u32 m0, s60, 65536
    s_add_u32 s53, s75, 237568
    buffer_load_dwordx4 v7, s[36:39], s53 offen sc1 lds
L_SH4_4:
    v_cmp_eq_u32 vcc, -1, v69
    s_cbranch_vccz L_SH4_5
    s_add_u32 m0, s60, 69632
    s_add_u32 s53, s76, 237568
    buffer_load_dwordx4 v7, s[36:39], s53 offen sc1 lds
L_SH4_5:
    v_cmp_eq_u32 vcc, -1, v70
    s_cbranch_vccz L_SH4_6
    s_add_u32 m0, s60, 73728
    s_add_u32 s53, s77, 237568
    buffer_load_dwordx4 v7, s[36:39], s53 offen sc1 lds
L_SH4_6:
    s_waitcnt vmcnt(0)
    ds_read_b32 v64, v11 offset:0
    ds_read_b32 v65, v11 offset:4096
    ds_read_b32 v66, v11 offset:8192
    ds_read_b32 v67, v11 offset:12288
    ds_read_b32 v68, v11 offset:16384
    ds_read_b32 v69, v11 offset:20480
    ds_read_b32 v70, v11 offset:24576
    s_waitcnt lgkmcnt(0)
    v_max3_u32 v3, v64, v65, v66
    v_max3_u32 v4, v67, v68, v69
    v_max3_u32 v3, v3, v4, v70
    v_cmp_eq_u32 vcc, -1, v3
    s_cbranch_vccnz L_RH4
    s_branch L_OKH4
L_FBH4:
    s_mov_b32 s62, 0x20000
    s_mov_b64 exec, 0x3fff
L_POLLFH4:
    buffer_load_dword v3, v9, s[36:39], 0 offen offset:64 sc1
    s_waitcnt vmcnt(0)
L_PCFH4:
    v_cmp_ne_u32 vcc, s61, v3
    s_cbranch_vccz L_GOFH4
    s_sub_u32 s62, s62, 1
    s_cbranch_scc1 L_GOFH4
    s_sleep 4
    s_branch L_POLLFH4
L_GOFH4:
    s_mov_b64 exec, -1
    s_add_u32 m0, s60, 49152
    s_add_u32 s53, s71, 237568
    buffer_load_dwordx4 v7, s[36:39], s53 offen sc1 lds
    s_add_u32 m0, s60, 53248
    s_add_u32 s53, s72, 237568
    buffer_load_dwordx4 v7, s[36:39], s53 offen sc1 lds
    s_add_u32 m0, s60, 57344
    s_add_u32 s53, s73, 237568
    buffer_load_dwordx4 v7, s[36:39], s53 offen sc1 lds
    s_add_u32 m0, s60, 61440
    s_add_u32 s53, s74, 237568
    buffer_load_dwordx4 v7, s[36:39], s53 offen sc1 lds
    s_add_u32 m0, s60, 65536
    s_add_u32 s53, s75, 237568
    buffer_load_dwordx4 v7, s[36:39], s53 offen sc1 lds
    s_add_u32 m0, s60, 69632
    s_add_u32 s53, s76, 237568
    buffer_load_dwordx4 v7, s[36:39], s53 offen sc1 lds
    s_add_u32 m0, s60, 73728
    s_add_u32 s53, s77, 237568
    buffer_load_dwordx4 v7, s[36:39], s53 offen sc1 lds
    s_waitcnt vmcnt(0)
    s_branch L_OKH4
L_RH5:
    s_sub_u32 s62, s62, 1
    s_cbranch_scc1 L_FBH5
    v_cmp_eq_u32 vcc, -1, v64
    s_cbranch_vccz L_SH5_0
    s_add_u32 m0, s60, 77824
    s_add_u32 s53, s71, 712704
    buffer_load_dwordx4 v7, s[36:39], s53 offen sc1 lds
L_SH5_0:
    v_cmp_eq_u32 vcc, -1, v65
    s_cbranch_vccz L_SH5_1
    s_add_u32 m0, s60, 81920
    s_add_u32 s53, s72, 712704
    buffer_load_dwordx4 v7, s[36:39], s53 offen sc1 lds
L_SH5_1:
    v_cmp_eq_u32 vcc, -1, v66
    s_cbranch_vccz L_SH5_2
    s_add_u32 m0, s60, 86016
    s_add_u32 s53, s73, 712704
    buffer_load_dwordx4 v7, s[36:39], s53 offen sc1 lds
L_SH5_2:
    v_cmp_eq_u32 vcc, -1, v67
    s_cbranch_vccz L_SH5_3
    s_add_u32 m0, s60, 90112
    s_add_u32 s53, s74, 712704
    buffer_load_dwordx4 v7, s[36:39], s53 offen sc1 lds
L_SH5_3:
    v_cmp_eq_u32 vcc, -1, v68
    s_cbranch_vccz L_SH5_4
    s_add_u32 m0, s60, 94208
    s_add_u32 s53, s75, 712704
    buffer_load_dwordx4 v7, s[36:39], s53 offen sc1 lds
L_SH5_4:
    v_cmp_eq_u32 vcc, -1, v69
    s_cbranch_vccz L_SH5_5
    s_add_u32 m0, s60, 98304
    s_add_u32 s53, s76, 712704
    buffer_load_dwordx4 v7, s[36:39], s53 offen sc1 lds
L_SH5_5:
    v_cmp_eq_u32 vcc, -1, v70
    s_cbranch_vccz L_SH5_6
    s_add_u32 m0, s60, 102400
    s_add_u32 s53, s77, 712704
    buffer_load_dwordx4 v7, s[36:39], s53 offen sc1 lds
L_SH5_6:
    s_waitcnt vmcnt(0)
    ds_read_b32 v64, v11 offset:28672
    ds_read_b32 v65, v11 offset:32768
    ds_read_b32 v66, v11 offset:36864
    ds_read_b32 v67, v11 offset:40960
    ds_read_b32 v68, v11 offset:45056
    ds_read_b32 v69, v11 offset:49152
    ds_read_b32 v70, v11 offset:53248
    s_waitcnt lgkmcnt(0)
    v_max3_u32 v3, v64, v65, v66
    v_max3_u32 v4, v67, v68, v69
    v_max3_u32 v3, v3, v4, v70
    v_cmp_eq_u32 vcc, -1, v3
    s_cbranch_vccnz L_RH5
    s_branch L_OKH5
L_FBH5:
    s_mov_b32 s62, 0x20000
    s_mov_b64 exec, 0x3fff
L_POLLFH5:
    buffer_load_dword v3, v9, s[36:39], 0 offen offset:64 sc1
    s_waitcnt vmcnt(0)
L_PCFH5:
    v_cmp_ne_u32 vcc, s61, v3
    s_cbranch_vccz L_GOFH5
    s_sub_u32 s62, s62, 1
    s_cbranch_scc1 L_GOFH5
    s_sleep 4
    s_branch L_POLLFH5
L_GOFH5:
    s_mov_b64 exec, -1
    s_add_u32 m0, s60, 77824
    s_add_u32 s53, s71, 712704
    buffer_load_dwordx4 v7, s[36:39], s53 offen sc1 lds
    s_add_u32 m0, s60, 81920
    s_add_u32 s53, s72, 712704
    buffer_load_dwordx4 v7, s[36:39], s53 offen sc1 lds
    s_add_u32 m0, s60, 86016
    s_add_u32 s53, s73, 712704
    buffer_load_dwordx4 v7, s[36:39], s53 offen sc1 lds
    s_add_u32 m0, s60, 90112
    s_add_u32 s53, s74, 712704
    buffer_load_dwordx4 v7, s[36:39], s53 offen sc1 lds
    s_add_u32 m0, s60, 94208
    s_add_u32 s53, s75, 712704
    buffer_load_dwordx4 v7, s[36:39], s53 offen sc1 lds
    s_add_u32 m0, s60, 98304
    s_add_u32 s53, s76, 712704
    buffer_load_dwordx4 v7, s[36:39], s53 offen sc1 lds
    s_add_u32 m0, s60, 102400
    s_add_u32 s53, s77, 712704
    buffer_load_dwordx4 v7, s[36:39], s53 offen sc1 lds
    s_waitcnt vmcnt(0)
    s_branch L_OKH5
L_RH6:
    s_sub_u32 s62, s62, 1
    s_cbranch_scc1 L_FBH6
    v_cmp_eq_u32 vcc, -1, v64
    s_cbranch_vccz L_SH6_0
    s_add_u32 m0, s60, 106496
    s_add_u32 s53, s71, 356352
    buffer_load_dwordx4 v7, s[36:39], s53 offen sc1 lds
L_SH6_0:
    v_cmp_eq_u32 vcc, -1, v65
    s_cbranch_vccz L_SH6_1
    s_add_u32 m0, s60, 110592
    s_add_u32 s53, s72, 356352
    buffer_load_dwordx4 v7, s[36:39], s53 offen sc1 lds
L_SH6_1:
    v_cmp_eq_u32 vcc, -1, v66
    s_cbranch_vccz L_SH6_2
    s_add_u32 m0, s60, 114688
    s_add_u32 s53, s73, 356352
    buffer_load_dwordx4 v7, s[36:39], s53 offen sc1 lds
L_SH6_2:
    v_cmp_eq_u32 vcc, -1, v67
    s_cbranch_vccz L_SH6_3
    s_add_u32 m0, s60, 118784
    s_add_u32 s53, s74, 356352
    buffer_load_dwordx4 v7, s[36:39], s53 offen sc1 lds
L_SH6_3:
    v_cmp_eq_u32 vcc, -1, v68
    s_cbranch_vccz L_SH6_4
    s_add_u32 m0, s60, 122880
    s_add_u32 s53, s75, 356352
    buffer_load_dwordx4 v7, s[36:39], s53 offen sc1 lds
L_SH6_4:
    v_cmp_eq_u32 vcc, -1, v69
    s_cbranch_vccz L_SH6_5
    s_add_u32 m0, s60, 126976
    s_add_u32 s53, s76, 356352
    buffer_load_dwordx4 v7, s[36:39], s53 offen sc1 lds
L_SH6_5:
    v_cmp_eq_u32 vcc, -1, v70
    s_cbranch_vccz L_SH6_6
    s_add_u32 m0, s60, 131072
    s_add_u32 s53, s77, 356352
    buffer_load_dwordx4 v7, s[36:39], s53 offen sc1 lds
L_SH6_6:
    s_waitcnt vmcnt(0)
    ds_read_b32 v64, v12 offset:0
    ds_read_b32 v65, v12 offset:4096
    ds_read_b32 v66, v12 offset:8192
    ds_read_b32 v67, v12 offset:12288
    ds_read_b32 v68, v12 offset:16384
    ds_read_b32 v69, v12 offset:20480
    ds_read_b32 v70, v12 offset:24576
    s_waitcnt lgkmcnt(0)
    v_max3_u32 v3, v64, v65, v66
    v_max3_u32 v4, v67, v68, v69
    v_max3_u32 v3, v3, v4, v70
    v_cmp_eq_u32 vcc, -1, v3
    s_cbranch_vccnz L_RH6
    s_branch L_OKH6
L_FBH6:
    s_mov_b32 s62, 0x20000
    s_mov_b64 exec, 0x3fff
L_POLLFH6:
    buffer_load_dword v3, v9, s[36:39], 0 offen offset:64 sc1
    s_waitcnt vmcnt(0)
L_PCFH6:
    v_cmp_ne_u32 vcc, s61, v3
    s_cbranch_vccz L_GOFH6
    s_sub_u32 s62, s62, 1
    s_cbranch_scc1 L_GOFH6
    s_sleep 4
    s_branch L_POLLFH6
L_GOFH6:
    s_mov_b64 exec, -1
    s_add_u32 m0, s60, 106496
    s_add_u32 s53, s71, 356352
    buffer_load_dwordx4 v7, s[36:39], s53 offen sc1 lds
    s_add_u32 m0, s60, 110592
    s_add_u32 s53, s72, 356352
    buffer_load_dwordx4 v7, s[36:39], s53 offen sc1 lds
    s_add_u32 m0, s60, 114688
    s_add_u32 s53, s73, 356352
    buffer_load_dwordx4 v7, s[36:39], s53 offen sc1 lds
    s_add_u32 m0, s60, 118784
    s_add_u32 s53, s74, 356352
    buffer_load_dwordx4 v7, s[36:39], s53 offen sc1 lds
    s_add_u32 m0, s60, 122880
    s_add_u32 s53, s75, 356352
    buffer_load_dwordx4 v7, s[36:39], s53 offen sc1 lds
    s_add_u32 m0, s60, 126976
    s_add_u32 s53, s76, 356352
    buffer_load_dwordx4 v7, s[36:39], s53 offen sc1 lds
    s_add_u32 m0, s60, 131072
    s_add_u32 s53, s77, 356352
    buffer_load_dwordx4 v7, s[36:39], s53 offen sc1 lds
    s_waitcnt vmcnt(0)
    s_branch L_OKH6
L_RH7:
    s_sub_u32 s62, s62, 1
    s_cbranch_scc1 L_FBH7
    v_cmp_eq_u32 vcc, -1, v64
    s_cbranch_vccz L_SH7_0
    s_add_u32 m0, s60, 135168
    s_add_u32 s53, s71, 831488
    buffer_load_dwordx4 v7, s[36:39], s53 offen sc1 lds
L_SH7_0:
    v_cmp_eq_u32 vcc, -1, v65
    s_cbranch_vccz L_SH7_1
    s_add_u32 m0, s60, 139264
    s_add_u32 s53, s72, 831488
    buffer_load_dwordx4 v7, s[36:39], s53 offen sc1 lds
L_SH7_1:
    v_cmp_eq_u32 vcc, -1, v66
    s_cbranch_vccz L_SH7_2
    s_add_u32 m0, s60, 143360
    s_add_u32 s53, s73, 831488
    buffer_load_dwordx4 v7, s[36:39], s53 offen sc1 lds
L_SH7_2:
    v_cmp_eq_u32 vcc, -1, v67
    s_cbranch_vccz L_SH7_3
    s_add_u32 m0, s60, 147456
    s_add_u32 s53, s74, 831488
    buffer_load_dwordx4 v7, s[36:39], s53 offen sc1 lds
L_SH7_3:
    v_cmp_eq_u32 vcc, -1, v68
    s_cbranch_vccz L_SH7_4
    s_add_u32 m0, s60, 151552
    s_add_u32 s53, s75, 831488
    buffer_load_dwordx4 v7, s[36:39], s53 offen sc1 lds
L_SH7_4:
    v_cmp_eq_u32 vcc, -1, v69
    s_cbranch_vccz L_SH7_5
    s_add_u32 m0, s60, 155648
    s_add_u32 s53, s76, 831488
    buffer_load_dwordx4 v7, s[36:39], s53 offen sc1 lds
L_SH7_5:
    v_cmp_eq_u32 vcc, -1, v70
    s_cbranch_vccz L_SH7_6
    s_add_u32 m0, s60, 159744
    s_add_u32 s53, s77, 831488
    buffer_load_dwordx4 v7, s[36:39], s53 offen sc1 lds
L_SH7_6:
    s_waitcnt vmcnt(0)
    ds_read_b32 v64, v12 offset:28672
    ds_read_b32 v65, v12 offset:32768
    ds_read_b32 v66, v12 offset:36864
    ds_read_b32 v67, v12 offset:40960
    ds_read_b32 v68, v12 offset:45056
    ds_read_b32 v69, v12 offset:49152
    ds_read_b32 v70, v12 offset:53248
    s_waitcnt lgkmcnt(0)
    v_max3_u32 v3, v64, v65, v66
    v_max3_u32 v4, v67, v68, v69
    v_max3_u32 v3, v3, v4, v70
    v_cmp_eq_u32 vcc, -1, v3
    s_cbranch_vccnz L_RH7
    s_branch L_OKH7
L_FBH7:
    s_mov_b32 s62, 0x20000
    s_mov_b64 exec, 0x3fff
L_POLLFH7:
    buffer_load_dword v3, v9, s[36:39], 0 offen offset:64 sc1
    s_waitcnt vmcnt(0)
L_PCFH7:
    v_cmp_ne_u32 vcc, s61, v3
    s_cbranch_vccz L_GOFH7
    s_sub_u32 s62, s62, 1
    s_cbranch_scc1 L_GOFH7
    s_sleep 4
    s_branch L_POLLFH7
L_GOFH7:
    s_mov_b64 exec, -1
    s_add_u32 m0, s60, 135168
    s_add_u32 s53, s71, 831488
    buffer_load_dwordx4 v7, s[36:39], s53 offen sc1 lds
    s_add_u32 m0, s60, 139264
    s_add_u32 s53, s72, 831488
    buffer_load_dwordx4 v7, s[36:39], s53 offen sc1 lds
    s_add_u32 m0, s60, 143360
    s_add_u32 s53, s73, 831488
    buffer_load_dwordx4 v7, s[36:39], s53 offen sc1 lds
    s_add_u32 m0, s60, 147456
    s_add_u32 s53, s74, 831488
    buffer_load_dwordx4 v7, s[36:39], s53 offen sc1 lds
    s_add_u32 m0, s60, 151552
    s_add_u32 s53, s75, 831488
    buffer_load_dwordx4 v7, s[36:39], s53 offen sc1 lds
    s_add_u32 m0, s60, 155648
    s_add_u32 s53, s76, 831488
    buffer_load_dwordx4 v7, s[36:39], s53 offen sc1 lds
    s_add_u32 m0, s60, 159744
    s_add_u32 s53, s77, 831488
    buffer_load_dwordx4 v7, s[36:39], s53 offen sc1 lds
    s_waitcnt vmcnt(0)
    s_branch L_OKH7
L_SL1:
    s_mov_b32 s62, 0x20000
L_SLL1:
    s_add_u32 s53, s7, 8192
    buffer_load_dwordx4 v[88:91], v7, s[36:39], s53 offen offset:0 sc1
    buffer_load_dwordx4 v[92:95], v7, s[36:39], s53 offen offset:1024 sc1
    s_add_u32 s53, s7, 24576
    buffer_load_dwordx4 v[104:107], v7, s[36:39], s53 offen offset:0 sc1
    buffer_load_dwordx4 v[108:111], v7, s[36:39], s53 offen offset:1024 sc1
    s_waitcnt vmcnt(0)
    v_xor_b32 v88, v24, v88
    v_xor_b32 v89, v25, v89
    v_xor_b32 v90, v26, v90
    v_xor_b32 v91, v27, v91
    v_xor_b32 v92, v24, v92
    v_xor_b32 v93, v25, v93
    v_xor_b32 v94, v26, v94
    v_xor_b32 v95, v27, v95
    v_or3_b32 v73, v88, v89, v90
    v_or3_b32 v73, v73, v91, v92
    v_or3_b32 v73, v73, v93, v94
    v_or_b32 v73, v73, v95
    v_xor_b32 v104, v24, v104
    v_xor_b32 v105, v25, v105
    v_xor_b32 v106, v26, v106
    v_xor_b32 v107, v27, v107
    v_xor_b32 v108, v24, v108
    v_xor_b32 v109, v25, v109
    v_xor_b32 v110, v26, v110
    v_xor_b32 v111, v27, v111
    v_or3_b32 v73, v73, v104, v105
    v_or3_b32 v73, v73, v106, v107
    v_or3_b32 v73, v73, v108, v109
    v_or3_b32 v73, v73, v110, v111
    v_add_f32 v88, v88, v104
    v_add_f32 v89, v89, v105
    v_add_f32 v90, v90, v106
    v_add_f32 v91, v91, v107
    v_add_f32 v92, v92, v108
    v_add_f32 v93, v93, v109
    v_add_f32 v94, v94, v110
    v_add_f32 v95, v95, v111
    v_and_b32 v3, s11, v73
    v_cmp_ne_u32 vcc, 0, v3
    s_cbranch_vccz L_SLX1
    s_sub_u32 s62, s62, 1
    s_cbranch_scc0 L_SLL1
    s_branch L_SLX1
L_SL0:
    s_mov_b32 s62, 0x20000
L_SLL0:
    s_add_u32 s53, s7, 0
    buffer_load_dwordx4 v[80:83], v7, s[36:39], s53 offen offset:0 sc1
    buffer_load_dwordx4 v[84:87], v7, s[36:39], s53 offen offset:1024 sc1
    s_add_u32 s53, s7, 16384
    buffer_load_dwordx4 v[96:99], v7, s[36:39], s53 offen offset:0 sc1
    buffer_load_dwordx4 v[100:103], v7, s[36:39], s53 offen offset:1024 sc1
    s_waitcnt vmcnt(0)
    v_xor_b32 v80, v24, v80
    v_xor_b32 v81, v25, v81
    v_xor_b32 v82, v26, v82
    v_xor_b32 v83, v27, v83
L_PAD_tail.9:
    s_cbranch_execz L_RETL4
    v_xor_b32 v84, v24, v84
    v_xor_b32 v85, v25, v85
    v_xor_b32 v86, v26, v86
    v_xor_b32 v87, v27, v87
    v_or3_b32 v72, v80, v81, v82
    v_or3_b32 v72, v72, v83, v84
    v_or3_b32 v72, v72, v85, v86
    v_or_b32 v72, v72, v87
    v_xor_b32 v96, v24, v96
    v_xor_b32 v97, v25, v97
    v_xor_b32 v98, v26, v98
    v_xor_b32 v99, v27, v99
    v_xor_b32 v100, v24, v100
    v_xor_b32 v101, v25, v101
    v_xor_b32 v102, v26, v102
    v_xor_b32 v103, v27, v103
    v_or3_b32 v72, v72, v96, v97
    v_or3_b32 v72, v72, v98, v99
    v_or3_b32 v72, v72, v100, v101
    v_or3_b32 v72, v72, v102, v103
    v_add_f32 v80, v80, v96
    v_add_f32 v81, v81, v97
    v_add_f32 v82, v82, v98
    v_add_f32 v83, v83, v99
    v_add_f32 v84, v84, v100
    v_add_f32 v85, v85, v101
    v_add_f32 v86, v86, v102
    v_add_f32 v87, v87, v103
    v_and_b32 v3, s11, v72
    v_cmp_ne_u32 vcc, 0, v3
    s_cbranch_vccz L_SLX0
    s_sub_u32 s62, s62, 1
    s_cbranch_scc0 L_SLL0
    s_branch L_SLX0
L_W:
    s_mov_b32 s62, 0x10000
    s_add_u32 s53, s7, 32768
    buffer_load_dwordx4 v[128:131], v7, s[36:39], s53 offen offset:0 sc1
    buffer_load_dwordx4 v[132:135], v7, s[36:39], s53 offen offset:1024 sc1
    s_add_u32 s53, s7, 40960
    buffer_load_dwordx4 v[120:123], v7, s[36:39], s53 offen offset:0 sc1
    buffer_load_dwordx4 v[124:127], v7, s[36:39], s53 offen offset:1024 sc1
    s_sleep 4
L_W1:
    s_add_u32 s53, s7, 32768
    buffer_load_dwordx4 v[136:139], v7, s[36:39], s53 offen offset:0 sc1
    buffer_load_dwordx4 v[140:143], v7, s[36:39], s53 offen offset:1024 sc1
    s_add_u32 s53, s7, 40960
    buffer_load_dwordx4 v[120:123], v7, s[36:39], s53 offen offset:0 sc1
    buffer_load_dwordx4 v[124:127], v7, s[36:39], s53 offen offset:1024 sc1
    s_waitcnt vmcnt(6)
    v_xor_b32 v112, v24, v128
    v_xor_b32 v113, v25, v129
    v_xor_b32 v114, v26, v130
    v_xor_b32 v115, v27, v131
    v_xor_b32 v116, v24, v132
    v_xor_b32 v117, v25, v133
    v_xor_b32 v118, v26, v134
    v_xor_b32 v119, v27, v135
    v_or3_b32 v4, v112, v113, v114
    v_or3_b32 v4, v4, v115, v116
    v_or3_b32 v4, v4, v117, v118
    v_or_b32 v4, v4, v119
    v_and_b32 v3, s11, v4
    v_cmp_ne_u32 vcc, 0, v3
    s_cbranch_vccz L_WOK
    s_add_u32 s53, s7, 32768
    buffer_load_dwordx4 v[128:131], v7, s[36:39], s53 offen offset:0 sc1
    buffer_load_dwordx4 v[132:135], v7, s[36:39], s53 offen offset:1024 sc1
    s_add_u32 s53, s7, 40960
    buffer_load_dwordx4 v[120:123], v7, s[36:39], s53 offen offset:0 sc1
    buffer_load_dwordx4 v[124:127], v7, s[36:39], s53 offen offset:1024 sc1
    s_waitcnt vmcnt(6)
    v_xor_b32 v112, v24, v136
    v_xor_b32 v113, v25, v137
    v_xor_b32 v114, v26, v138
    v_xor_b32 v115, v27, v139
    v_xor_b32 v116, v24, v140
    v_xor_b32 v117, v25, v141
    v_xor_b32 v118, v26, v142
    v_xor_b32 v119, v27, v143
    v_or3_b32 v4, v112, v113, v114
    v_or3_b32 v4, v4, v115, v116
    v_or3_b32 v4, v4, v117, v118
    v_or_b32 v4, v4, v119
    v_and_b32 v3, s11, v4
    v_cmp_ne_u32 vcc, 0, v3
    s_cbranch_vccz L_WOK
    s_sub_u32 s62, s62, 1
    s_cbranch_scc0 L_W1
L_WOK:
    s_add_u32 s53, s7, 40960
    buffer_load_dwordx4 v[240:243], v7, s[36:39], s53 offen offset:0 sc1
    buffer_load_dwordx4 v[244:247], v7, s[36:39], s53 offen offset:1024 sc1
    s_branch L_WX
L_Y:
    s_mov_b32 s62, 0x10000
L_Y1:
    s_add_u32 s53, s7, 40960
    buffer_load_dwordx4 v[248:251], v7, s[36:39], s53 offen offset:0 sc1
    buffer_load_dwordx4 v[252:255], v7, s[36:39], s53 offen offset:1024 sc1
    s_waitcnt vmcnt(2)
    v_xor_b32 v120, v24, v240
    v_xor_b32 v121, v25, v241
    v_xor_b32 v122, v26, v242
    v_xor_b32 v123, v27, v243
    v_xor_b32 v124, v24, v244
    v_xor_b32 v125, v25, v245
    v_xor_b32 v126, v26, v246
    v_xor_b32 v127, v27, v247
    v_or3_b32 v4, v120, v121, v122
    v_or3_b32 v4, v4, v123, v124
    v_or3_b32 v4, v4, v125, v126
    v_or_b32 v4, v4, v127
    v_and_b32 v3, s11, v4
    v_cmp_ne_u32 vcc, 0, v3
    s_cbranch_vccz L_YOK
    s_add_u32 s53, s7, 40960
    buffer_load_dwordx4 v[240:243], v7, s[36:39], s53 offen offset:0 sc1
    buffer_load_dwordx4 v[244:247], v7, s[36:39], s53 offen offset:1024 sc1
    s_waitcnt vmcnt(2)
    v_xor_b32 v120, v24, v248
    v_xor_b32 v121, v25, v249
    v_xor_b32 v122, v26, v250
    v_xor_b32 v123, v27, v251
    v_xor_b32 v124, v24, v252
    v_xor_b32 v125, v25, v253
    v_xor_b32 v126, v26, v254
    v_xor_b32 v127, v27, v255
    v_or3_b32 v4, v120, v121, v122
    v_or3_b32 v4, v4, v123, v124
    v_or3_b32 v4, v4, v125, v126
    v_or_b32 v4, v4, v127
    v_and_b32 v3, s11, v4
    v_cmp_ne_u32 vcc, 0, v3
    s_cbranch_vccz L_YOK
    s_sub_u32 s62, s62, 1
    s_cbranch_scc0 L_Y1
L_YOK:
    v_add_f32 v120, v120, v88
    v_add_f32 v121, v121, v89
    v_add_f32 v122, v122, v90
    v_add_f32 v123, v123, v91
    v_add_f32 v124, v124, v92
    v_add_f32 v125, v125, v93
    v_add_f32 v126, v126, v94
    v_add_f32 v127, v127, v95
    s_branch L_X2
L_CEND:
.section .rodata,"a"
.p2align 6
.amdhsa_kernel standalone__swiglu_ffn__sampling_kernel
  .amdhsa_next_free_vgpr 256
  .amdhsa_next_free_sgpr 102
  .amdhsa_accum_offset 256
  .amdhsa_group_segment_fixed_size 0
  .amdhsa_kernarg_size 56
  .amdhsa_user_sgpr_count 2
  .amdhsa_user_sgpr_kernarg_segment_ptr 1
  .amdhsa_system_sgpr_workgroup_id_x 1
.end_amdhsa_kernel
```
